```python
import torch

def _softmax(x, axis=-1):
    return torch.softmax(x, dim=axis)
def _gelu(x):
    return torch.nn.functional.gelu(x, approximate="tanh")
def _silu(x):
    return torch.nn.functional.silu(x)
def _sigmoid(x):
    return torch.sigmoid(x)
def _layernorm(x, axis=-1, eps=1e-5):
    m = x.mean(dim=axis, keepdim=True)
    v = x.var(dim=axis, keepdim=True, unbiased=False)
    return (x - m) / torch.sqrt(v + eps)
def _scatter_add(tgt, idx, src, axis=0):
    return tgt.clone().index_add_(axis, idx, src)
def _segment_sum(src, seg, n):
    out = torch.zeros((n,) + src.shape[1:], dtype=src.dtype)
    return out.index_add_(0, seg, src)
def _pad(x, pw):
    flat = tuple(v for pair in reversed(pw) for v in pair)
    return torch.nn.functional.pad(x, flat)

kernel_name = 'recurrent_scan__sliding_block_cached__mixer_token_mlp__decode'

def setup_inputs():

    _w = (lambda a: (lambda t: t.to(torch.bfloat16) if t.is_floating_point() else t)(torch.as_tensor(a)))
    def _A_setup():
        B, Sq, D = 4, 1, 576
        Hq, Hkv, Sk, Dh = 32, 16, 8192, 128
        assert Hq % Hkv == 0, (Hq, Hkv)
        return {
            "x": _w((lambda *s: torch.randn(*s, dtype=torch.bfloat16) * 0.05)(B, Sq, D)),
            "k_cache": _w((lambda *s: torch.randn(*s, dtype=torch.bfloat16) * 1.6)(B, Hkv, Sk, Dh)),
            "v_cache": _w((lambda *s: torch.randn(*s, dtype=torch.bfloat16) * 1.6)(B, Hkv, Sk, Dh)),
            "wq": _w((lambda *s: torch.randn(*s, dtype=torch.bfloat16) * 1.6)(D, Hq * Dh) * (D ** -0.5)),
            "wo": _w((lambda *s: torch.randn(*s, dtype=torch.bfloat16) * 1.6)(Hq * Dh, D) * ((Hq * Dh) ** -0.5)),
        }
    _A_in = _A_setup()

    def _B_setup():
        B, S, D, F = 4, 1, 576, 4608
        return {
            "x": _w((lambda *s: torch.randn(*s, dtype=torch.bfloat16) * 0.05)(B, S, D)),
            "w1": _w((lambda *s: torch.randn(*s, dtype=torch.bfloat16) * 0.2)(S, F) * (S ** -0.5)),
            "b1": _w((lambda *s: torch.randn(*s, dtype=torch.bfloat16) * 0.2)(F) * 0.02),
            "w2": _w((lambda *s: torch.randn(*s, dtype=torch.bfloat16) * 0.2)(F, S) * (F ** -0.5)),
            "b2": _w((lambda *s: torch.randn(*s, dtype=torch.bfloat16) * 0.2)(S) * 0.02),
        }
    _B_in = _B_setup()

    return {
        "A_x": _A_in["x"],
        "A_k_cache": _A_in["k_cache"],
        "A_v_cache": _A_in["v_cache"],
        "A_wq": _A_in["wq"],
        "A_wo": _A_in["wo"],
        "B_x": _B_in["x"],
        "B_w1": _B_in["w1"],
        "B_b1": _B_in["b1"],
        "B_w2": _B_in["w2"],
        "B_b2": _B_in["b2"],
    }

def reference(A_x, A_k_cache, A_v_cache, A_wq, A_wo, B_x, B_w1, B_b1, B_w2, B_b2):
    def _A_ref(x, k_cache, v_cache, wq, wo):
        B, Sq, D = x.shape
        Hq, Dh = 32, 128
        Hkv, Sk = k_cache.shape[1], k_cache.shape[2]
        W = min(4096, max(256, Sk // 4))
        rep = Hq // Hkv
        q = (lambda x, *d: x.permute(*d))((x @ wq).reshape(B, Sq, Hq, Dh), 0, 2, 1, 3)
        k = (lambda x, n, axis: torch.repeat_interleave(x, n, dim=axis))(k_cache[:, :, Sk - W:, :], rep, axis=1)
        v = (lambda x, n, axis: torch.repeat_interleave(x, n, dim=axis))(v_cache[:, :, Sk - W:, :], rep, axis=1)
        scores = torch.einsum("bhqd,bhkd->bhqk", q, k) * (Dh ** -0.5)
        p = _softmax(scores, axis=-1)
        o = torch.einsum("bhqk,bhkd->bhqd", p, v)
        return (lambda x, *d: x.permute(*d))(o, 0, 2, 1, 3).reshape(B, Sq, Hq * Dh) @ wo

    def _B_ref(x, w1, b1, w2, b2):
        B, S, D = x.shape
        h = _layernorm(x, axis=-1)
        u = torch.einsum("bsd,sf->bdf", h, w1) + b1
        u = _gelu(u)
        y = torch.einsum("bdf,fs->bds", u, w2) + b2
        return (lambda x, *d: x.permute(*d))(y, 0, 2, 1)

    x = A_x
    xn = _layernorm(x, axis=-1)
    s = _A_ref(xn, A_k_cache, A_v_cache, A_wq, A_wo)
    g = _silu(_B_ref(xn, B_w1, B_b1, B_w2, B_b2))
    return x + s * g
```

```asm
; @launch grid=(256,1,1) block=(1024,1,1) lds=158976
.amdgcn_target "amdgcn-amd-amdhsa--gfx950"
.text
.globl recurrent_scan__sliding_block_cached__mixer_token_mlp__decode_kernel
.p2align 8
.type recurrent_scan__sliding_block_cached__mixer_token_mlp__decode_kernel,@function
recurrent_scan__sliding_block_cached__mixer_token_mlp__decode_kernel:
  s_cmp_ge_u32 s2, 256
  s_cbranch_scc1 L_exit
  s_load_dwordx16 s[4:19], s[0:1], 0
  s_load_dwordx8 s[20:27], s[0:1], 64
  s_load_dwordx2 s[28:29], s[0:1], 96
  v_lshrrev_b32 v1, 6, v0
  v_and_b32 v0, 63, v0
  v_readfirstlane_b32 s3, v1
  s_and_b32 s30, s2, 15
  s_lshr_b32 s31, s2, 4
  s_lshr_b32 s32, s31, 2
  s_and_b32 s33, s31, 3
  s_lshl_b32 s35, s32, 4
  s_add_u32 s35, s35, s30
  s_mov_b32 s96, 0xe3f2e10f
  s_mov_b32 s97, 0xf876ef54
  s_lshl_b32 s44, s31, 2
  s_lshr_b64 s[96:97], s[96:97], s44
  s_and_b32 s96, s96, 15
  s_lshl_b32 s96, s96, 4
  s_add_u32 s96, s96, s30
  s_mov_b32 s62, 0
  s_mov_b32 s39, 0x20000
  s_mov_b32 s43, 0x20000
  v_lshlrev_b32 v1, 4, v0
  v_lshrrev_b32 v2, 4, v0
  s_cmp_lt_u32 s3, 8
  s_cbranch_scc0 L_S
  s_cmp_lt_u32 s3, 4
  s_cbranch_scc0 L_M
  s_setprio 3
  s_mul_i32 s44, s3, 1152
  s_movk_i32 s38, 1152
  v_lshlrev_b32 v14, 1, v0
  s_cmp_lg_u32 s3, 0
  s_cbranch_scc1 L_noinit
  v_mov_b32 v4, 0
  v_mov_b32 v5, 0
  v_mov_b32 v6, 0
  v_mov_b32 v7, 0
  v_add_u32 v3, 157952, v1
  ds_write_b128 v3, v[4:7]
L_noinit:
  s_waitcnt lgkmcnt(0)
  s_add_u32 s36, s4, s44
  s_addc_u32 s37, s5, 0
  buffer_load_dwordx4 v[16:19], v1, s[36:39], 0 offen
  buffer_load_ushort v20, v14, s[36:39], 0 offen offset:1024
  s_load_dwordx2 s[60:61], s[28:29], 0
  s_barrier
  s_branch L_A
L_M:
  s_setprio 2
  s_sub_u32 s34, s3, 4
  s_lshr_b32 s46, s2, 3
  s_waitcnt lgkmcnt(0)
  s_cmp_lg_u32 s34, 3
  s_cbranch_scc1 L_nowarmc
  s_cmp_lt_u32 s46, (L_code_end-recurrent_scan__sliding_block_cached__mixer_token_mlp__decode_kernel)>>10
  s_cbranch_scc0 L_nowarmc
  s_getpc_b64 s[44:45]
L_pc:
  s_sub_u32 s44, s44, L_pc-recurrent_scan__sliding_block_cached__mixer_token_mlp__decode_kernel
  s_subb_u32 s45, s45, 0
  s_lshl_b32 s46, s46, 10
  v_add_u32 v3, s46, v1
  global_load_dwordx4 v[88:91], v3, s[44:45]
L_nowarmc:
  s_cmp_lg_u32 s34, 2
  s_cbranch_scc1 L_nowarmw
  s_cmp_lt_u32 s46, 27
  s_cbranch_scc0 L_nowarmw
  s_mov_b64 s[44:45], s[16:17]
  s_cmp_lt_u32 s46, 9
  s_cbranch_scc1 L_warmw
  s_mov_b64 s[44:45], s[18:19]
  s_sub_u32 s46, s46, 9
  s_cmp_lt_u32 s46, 9
  s_cbranch_scc1 L_warmw
  s_mov_b64 s[44:45], s[20:21]
  s_sub_u32 s46, s46, 9
L_warmw:
  s_lshl_b32 s46, s46, 10
  v_add_u32 v3, s46, v1
  global_load_dwordx4 v[88:91], v3, s[44:45]
L_nowarmw:
  s_barrier
  s_cmp_lt_u32 s96, 144
  s_cbranch_scc0 L_end
  s_branch L_M2
L_S:
  s_setprio 1
  s_sub_u32 s34, s3, 8
  s_mul_i32 s44, s32, 1179648
  s_lshl_b32 s45, s30, 9
  s_add_u32 s44, s44, s45
  s_lshl_b32 s45, s33, 7
  s_add_u32 s44, s44, s45
  s_mov_b32 s42, 1171584
  v_lshrrev_b32 v4, 3, v0
  v_bfe_u32 v3, v0, 4, 2
  v_lshlrev_b32 v3, 1, v3
  v_and_b32 v5, 7, v0
  v_xor_b32 v3, v3, v5
  v_lshlrev_b32 v3, 4, v3
  v_lshl_add_u32 v4, v4, 13, v3
  s_lshl_b32 s45, s34, 10
  s_add_u32 m0, s45, 131072
  s_lshl_b32 s45, s34, 16
  s_lshl_b32 s46, s35, 21
  s_lshl_b32 s47, s33, 17
  s_add_u32 s46, s46, s47
  s_add_u32 s46, s46, 1572864
  s_mov_b32 s38, 131072
  s_lshl_b32 s47, s34, 14
  s_add_u32 s47, s47, s46
  s_mul_i32 s51, s2, 5
  s_add_u32 s51, s51, s31
  v_lshlrev_b32 v3, 6, v2
  v_xor_b32 v3, v1, v3
  v_mov_b32 v5, 157988
  v_mov_b32 v6, 1
  s_mov_b32 s50, s34
  s_waitcnt lgkmcnt(0)
  s_add_u32 s40, s10, s44
  s_addc_u32 s41, s11, 0
  s_add_u32 s36, s6, s46
  s_addc_u32 s37, s7, 0
L_wqloop:
  buffer_load_dwordx4 v4, s[40:43], s45 offen nt lds
  s_add_u32 m0, m0, 0x2000
  s_add_u32 s45, s45, 0x80000
  s_cmp_lt_u32 s45, 1179648
  s_cbranch_scc1 L_wqloop
L_wqdone:
  s_add_u32 s40, s8, s47
  s_addc_u32 s41, s9, 0
  s_movk_i32 s42, 0x4000
L_kloop:
  s_and_b32 s44, s50, 7
  s_lshr_b32 s45, s50, 3
  s_mul_i32 s46, s44, 3
  s_add_u32 s46, s46, s51
  s_add_u32 s46, s46, s45
  s_and_b32 s46, s46, 15
  s_lshl_b32 s44, s44, 4
  s_add_u32 s46, s46, s44
  s_lshl_b32 s46, s46, 10
  s_add_u32 s44, s44, s45
  s_lshl_b32 m0, s44, 10
  s_and_b32 s47, s45, 3
  s_lshl_b32 s47, s47, 4
  v_xor_b32 v4, s47, v3
  s_waitcnt vmcnt(3)
  buffer_load_dwordx4 v4, s[36:39], s46 offen nt lds
  s_cmp_lt_u32 s50, 8
  s_cbranch_scc0 L_knobar
  s_barrier
L_knobar:
  s_cmp_lt_u32 s50, 16
  s_cbranch_scc0 L_kdyn
  s_add_u32 s50, s50, 8
  s_branch L_kloop
L_kdyn:
  s_cmp_lt_u32 s50, 24
  s_cbranch_scc0 L_kdyn2
  s_add_u32 s50, s50, 8
  s_mov_b64 exec, 1
  ds_add_rtn_u32 v7, v5, v6
  s_mov_b64 exec, -1
  s_branch L_kloop
L_kdyn2:
  s_waitcnt lgkmcnt(0)
  v_readfirstlane_b32 s49, v7
  s_mov_b64 exec, 1
  ds_add_rtn_u32 v7, v5, v6
  s_cmp_lt_u32 s50, 32
  s_cbranch_scc0 L_knosig
  ds_add_u32 v5, v6 offset:4
L_knosig:
  s_mov_b64 exec, -1
  s_add_u32 s50, s49, 32
  s_cmp_lt_u32 s50, 128
  s_cbranch_scc1 L_kloop
  s_mul_i32 s46, s34, 3
  s_add_u32 s46, s46, s51
  s_and_b32 s46, s46, 15
  s_lshl_b32 s46, s46, 10
  s_movk_i32 s48, 0x400
  s_movk_i32 s49, 0x3fff
  s_waitcnt lgkmcnt(0)
  s_waitcnt vmcnt(3)
  buffer_load_dwordx4 v[64:67], v1, s[40:43], s46 offen nt
  s_add_u32 s46, s46, s48
  s_and_b32 s46, s46, s49
  s_waitcnt vmcnt(3)
  buffer_load_dwordx4 v[68:71], v1, s[40:43], s46 offen nt
  s_add_u32 s46, s46, s48
  s_and_b32 s46, s46, s49
  s_waitcnt vmcnt(3)
  buffer_load_dwordx4 v[72:75], v1, s[40:43], s46 offen nt
  s_add_u32 s46, s46, s48
  s_and_b32 s46, s46, s49
  s_waitcnt vmcnt(3)
  v_mov_b32 v4, 157960
  v_mov_b32 v5, 1
  s_mov_b64 exec, 1
  ds_add_u32 v4, v5
  s_mov_b64 exec, -1
  buffer_load_dwordx4 v[76:79], v1, s[40:43], s46 offen nt
  s_add_u32 s46, s46, s48
  s_and_b32 s46, s46, s49
  v_and_b32 v4, 1, v0
  v_cmp_eq_u32 vcc, 1, v4
  v_mov_b32 v5, 0xffff
  v_mov_b32 v6, 0xffff0000
  v_bfe_u32 v4, v0, 1, 2
  v_cndmask_b32 v5, v5, v6, vcc
  v_cmp_eq_u32 vcc, 0, v4
  s_nop 1
  v_cndmask_b32 v8, 0, v5, vcc
  v_cmp_eq_u32 vcc, 1, v4
  s_nop 1
  v_cndmask_b32 v9, 0, v5, vcc
  v_cmp_eq_u32 vcc, 2, v4
  s_nop 1
  v_cndmask_b32 v10, 0, v5, vcc
  v_cmp_eq_u32 vcc, 3, v4
  s_nop 1
  v_cndmask_b32 v11, 0, v5, vcc
  v_bfe_u32 v4, v0, 3, 1
  v_lshlrev_b32 v4, 11, v4
  v_lshl_add_u32 v4, v2, 6, v4
  s_lshl_b32 s44, s34, 8
  s_add_u32 s44, s44, 131072
  v_add_u32 v12, s44, v4
  v_mov_b32 v32, 0
  v_mov_b32 v33, 0
  v_mov_b32 v34, 0
  v_mov_b32 v35, 0
  v_and_b32 v5, 15, v0
  s_lshl_b32 s44, s35, 12
  s_add_u32 s44, s44, 655360
  s_lshl_b32 s45, s33, 10
  s_add_u32 s47, s45, s44
  v_add_u32 v13, s47, v1
  s_add_u32 s45, s45, 0x400
  s_and_b32 s45, s45, 0xfff
  s_add_u32 s47, s45, s44
  v_add_u32 v48, s47, v1
  s_add_u32 s45, s45, 0x400
  s_and_b32 s45, s45, 0xfff
  s_add_u32 s47, s45, s44
  v_add_u32 v49, s47, v1
  s_add_u32 s45, s45, 0x400
  s_and_b32 s45, s45, 0xfff
  s_add_u32 s47, s45, s44
  v_add_u32 v50, s47, v1
  v_add_u32 v14, 135168, v1
  v_lshrrev_b32 v4, 5, v0
  v_lshlrev_b32 v59, 4, v4
  v_add_u32 v59, 158080, v59
  v_lshlrev_b32 v4, 9, v4
  v_lshl_add_u32 v4, v5, 5, v4
  v_bfe_u32 v5, v0, 4, 1
  v_lshl_add_u32 v4, v5, 4, v4
  s_lshl_b32 s44, s34, 10
  s_add_u32 s44, s44, 135168
  v_add_u32 v15, s44, v4
  v_lshrrev_b32 v6, 3, v0
  v_lshlrev_b32 v6, 6, v6
  v_and_b32 v7, 3, v0
  v_lshl_add_u32 v6, v7, 4, v6
  v_bfe_u32 v7, v0, 2, 1
  v_lshl_add_u32 v6, v7, 3, v6
  v_add_u32 v58, 158464, v6
  s_cmp_ge_u32 s96, 240
  s_cbranch_scc1 L_v_own
  s_cmp_lt_u32 s96, 144
  s_cbranch_scc1 L_v_mlp
L_v_light:
  s_waitcnt vmcnt(2)
  buffer_load_dwordx4 v[80:83], v1, s[40:43], s46 offen nt
  s_add_u32 s46, s46, s48
  s_and_b32 s46, s46, s49
  s_waitcnt vmcnt(2)
  buffer_load_dwordx4 v[84:87], v1, s[40:43], s46 offen nt
  s_add_u32 s46, s46, s48
  s_and_b32 s46, s46, s49
  s_waitcnt vmcnt(2)
  buffer_load_dwordx4 v[88:91], v1, s[40:43], s46 offen nt
  s_add_u32 s46, s46, s48
  s_and_b32 s46, s46, s49
  s_waitcnt vmcnt(2)
  buffer_load_dwordx4 v[92:95], v1, s[40:43], s46 offen nt
  s_add_u32 s46, s46, s48
  s_and_b32 s46, s46, s49
  s_waitcnt vmcnt(2)
  buffer_load_dwordx4 v[96:99], v1, s[40:43], s46 offen nt
  s_add_u32 s46, s46, s48
  s_and_b32 s46, s46, s49
  s_waitcnt vmcnt(2)
  buffer_load_dwordx4 v[100:103], v1, s[40:43], s46 offen nt
  s_add_u32 s46, s46, s48
  s_and_b32 s46, s46, s49
  s_waitcnt vmcnt(2)
  buffer_load_dwordx4 v[104:107], v1, s[40:43], s46 offen nt
  s_add_u32 s46, s46, s48
  s_and_b32 s46, s46, s49
  s_waitcnt vmcnt(2)
  buffer_load_dwordx4 v[108:111], v1, s[40:43], s46 offen nt
  s_add_u32 s46, s46, s48
  s_and_b32 s46, s46, s49
  s_waitcnt vmcnt(2)
  buffer_load_dwordx4 v[112:115], v1, s[40:43], s46 offen nt
  s_add_u32 s46, s46, s48
  s_and_b32 s46, s46, s49
  s_waitcnt vmcnt(2)
  buffer_load_dwordx4 v[116:119], v1, s[40:43], s46 offen nt
  s_add_u32 s46, s46, s48
  s_and_b32 s46, s46, s49
  buffer_load_dwordx4 v[120:123], v1, s[40:43], s46 offen nt
  s_add_u32 s46, s46, s48
  s_and_b32 s46, s46, s49
  buffer_load_dwordx4 v[124:127], v1, s[40:43], s46 offen nt
  s_add_u32 s46, s46, s48
  s_and_b32 s46, s46, s49
  s_branch L_v_done
L_v_mlp:
  s_waitcnt vmcnt(5)
  buffer_load_dwordx4 v[80:83], v1, s[40:43], s46 offen nt
  s_add_u32 s46, s46, s48
  s_and_b32 s46, s46, s49
  s_waitcnt vmcnt(5)
  buffer_load_dwordx4 v[84:87], v1, s[40:43], s46 offen nt
  s_add_u32 s46, s46, s48
  s_and_b32 s46, s46, s49
  s_waitcnt vmcnt(5)
  buffer_load_dwordx4 v[88:91], v1, s[40:43], s46 offen nt
  s_add_u32 s46, s46, s48
  s_and_b32 s46, s46, s49
  s_waitcnt vmcnt(5)
  buffer_load_dwordx4 v[92:95], v1, s[40:43], s46 offen nt
  s_add_u32 s46, s46, s48
  s_and_b32 s46, s46, s49
  s_waitcnt vmcnt(5)
  buffer_load_dwordx4 v[96:99], v1, s[40:43], s46 offen nt
  s_add_u32 s46, s46, s48
  s_and_b32 s46, s46, s49
  s_waitcnt vmcnt(5)
  buffer_load_dwordx4 v[100:103], v1, s[40:43], s46 offen nt
  s_add_u32 s46, s46, s48
  s_and_b32 s46, s46, s49
  s_waitcnt vmcnt(5)
  buffer_load_dwordx4 v[104:107], v1, s[40:43], s46 offen nt
  s_add_u32 s46, s46, s48
  s_and_b32 s46, s46, s49
  s_waitcnt vmcnt(5)
  buffer_load_dwordx4 v[108:111], v1, s[40:43], s46 offen nt
  s_add_u32 s46, s46, s48
  s_and_b32 s46, s46, s49
  buffer_load_dwordx4 v[112:115], v1, s[40:43], s46 offen nt
  s_add_u32 s46, s46, s48
  s_and_b32 s46, s46, s49
  buffer_load_dwordx4 v[116:119], v1, s[40:43], s46 offen nt
  s_add_u32 s46, s46, s48
  s_and_b32 s46, s46, s49
  buffer_load_dwordx4 v[120:123], v1, s[40:43], s46 offen nt
  s_add_u32 s46, s46, s48
  s_and_b32 s46, s46, s49
  buffer_load_dwordx4 v[124:127], v1, s[40:43], s46 offen nt
  s_add_u32 s46, s46, s48
  s_and_b32 s46, s46, s49
  s_branch L_v_done
L_v_own:
  buffer_load_dwordx4 v[80:83], v1, s[40:43], s46 offen nt
  s_add_u32 s46, s46, s48
  s_and_b32 s46, s46, s49
  buffer_load_dwordx4 v[84:87], v1, s[40:43], s46 offen nt
  s_add_u32 s46, s46, s48
  s_and_b32 s46, s46, s49
  buffer_load_dwordx4 v[88:91], v1, s[40:43], s46 offen nt
  s_add_u32 s46, s46, s48
  s_and_b32 s46, s46, s49
  buffer_load_dwordx4 v[92:95], v1, s[40:43], s46 offen nt
  s_add_u32 s46, s46, s48
  s_and_b32 s46, s46, s49
  buffer_load_dwordx4 v[96:99], v1, s[40:43], s46 offen nt
  s_add_u32 s46, s46, s48
  s_and_b32 s46, s46, s49
  buffer_load_dwordx4 v[100:103], v1, s[40:43], s46 offen nt
  s_add_u32 s46, s46, s48
  s_and_b32 s46, s46, s49
  buffer_load_dwordx4 v[104:107], v1, s[40:43], s46 offen nt
  s_add_u32 s46, s46, s48
  s_and_b32 s46, s46, s49
  buffer_load_dwordx4 v[108:111], v1, s[40:43], s46 offen nt
  s_add_u32 s46, s46, s48
  s_and_b32 s46, s46, s49
  buffer_load_dwordx4 v[112:115], v1, s[40:43], s46 offen nt
  s_add_u32 s46, s46, s48
  s_and_b32 s46, s46, s49
  buffer_load_dwordx4 v[116:119], v1, s[40:43], s46 offen nt
  s_add_u32 s46, s46, s48
  s_and_b32 s46, s46, s49
  buffer_load_dwordx4 v[120:123], v1, s[40:43], s46 offen nt
  s_add_u32 s46, s46, s48
  s_and_b32 s46, s46, s49
  buffer_load_dwordx4 v[124:127], v1, s[40:43], s46 offen nt
  s_add_u32 s46, s46, s48
  s_and_b32 s46, s46, s49
L_v_done:
  v_mov_b32 v4, 157968
LW_1:
  ds_read_b32 v5, v4
  s_add_u32 s62, s62, 1
  s_cmp_gt_u32 s62, 0x2000000
  s_cbranch_scc1 L_end
  s_sleep 1
  s_waitcnt lgkmcnt(0)
  v_readfirstlane_b32 s46, v5
  s_nop 0
  s_cmp_lt_u32 s46, 4
  s_cbranch_scc1 LW_1
  s_setprio 3
  ds_read_b128 v[16:19], v12
  ds_read_b128 v[20:23], v12 offset:16
  ds_read_b128 v[24:27], v12 offset:32
  ds_read_b128 v[28:31], v12 offset:48
  v_mov_b32 v4, 158016
  ds_read_b64 v[4:5], v4
  s_waitcnt lgkmcnt(0)
  v_readfirstlane_b32 s60, v4
  v_readfirstlane_b32 s61, v5
  s_nop 1
  v_mov_b32 v41, s60
  v_mov_b32 v43, s61
  v_mov_b32 v45, s60
  v_mov_b32 v47, s61
  v_and_b32 v36, v16, v8
  v_and_b32 v37, v16, v9
  v_and_b32 v38, v16, v10
  v_and_b32 v39, v16, v11
  s_waitcnt vmcnt(15)
  s_nop 0
  v_mfma_f32_16x16x32_bf16 v[32:35], v[36:39], v[64:67], v[32:35]
  v_and_b32 v4, v17, v8
  v_and_b32 v5, v17, v9
  v_and_b32 v6, v17, v10
  v_and_b32 v7, v17, v11
  s_waitcnt vmcnt(14)
  s_nop 0
  v_mfma_f32_16x16x32_bf16 v[32:35], v[4:7], v[68:71], v[32:35]
  v_and_b32 v36, v18, v8
  v_and_b32 v37, v18, v9
  v_and_b32 v38, v18, v10
  v_and_b32 v39, v18, v11
  s_waitcnt vmcnt(13)
  s_nop 0
  v_mfma_f32_16x16x32_bf16 v[32:35], v[36:39], v[72:75], v[32:35]
  v_and_b32 v4, v19, v8
  v_and_b32 v5, v19, v9
  v_and_b32 v6, v19, v10
  v_and_b32 v7, v19, v11
  s_waitcnt vmcnt(12)
  s_nop 0
  v_mfma_f32_16x16x32_bf16 v[32:35], v[4:7], v[76:79], v[32:35]
  v_and_b32 v36, v20, v8
  v_and_b32 v37, v20, v9
  v_and_b32 v38, v20, v10
  v_and_b32 v39, v20, v11
  s_waitcnt vmcnt(11)
  s_nop 0
  v_mfma_f32_16x16x32_bf16 v[32:35], v[36:39], v[80:83], v[32:35]
  v_and_b32 v4, v21, v8
  v_and_b32 v5, v21, v9
  v_and_b32 v6, v21, v10
  v_and_b32 v7, v21, v11
  s_waitcnt vmcnt(10)
  s_nop 0
  v_mfma_f32_16x16x32_bf16 v[32:35], v[4:7], v[84:87], v[32:35]
  v_and_b32 v36, v22, v8
  v_and_b32 v37, v22, v9
  v_and_b32 v38, v22, v10
  v_and_b32 v39, v22, v11
  s_waitcnt vmcnt(9)
  s_nop 0
  v_mfma_f32_16x16x32_bf16 v[32:35], v[36:39], v[88:91], v[32:35]
  v_and_b32 v4, v23, v8
  v_and_b32 v5, v23, v9
  v_and_b32 v6, v23, v10
  v_and_b32 v7, v23, v11
  s_waitcnt vmcnt(8)
  s_nop 0
  v_mfma_f32_16x16x32_bf16 v[32:35], v[4:7], v[92:95], v[32:35]
  v_and_b32 v36, v24, v8
  v_and_b32 v37, v24, v9
  v_and_b32 v38, v24, v10
  v_and_b32 v39, v24, v11
  s_waitcnt vmcnt(7)
  s_nop 0
  v_mfma_f32_16x16x32_bf16 v[32:35], v[36:39], v[96:99], v[32:35]
  v_and_b32 v4, v25, v8
  v_and_b32 v5, v25, v9
  v_and_b32 v6, v25, v10
  v_and_b32 v7, v25, v11
  s_waitcnt vmcnt(6)
  s_nop 0
  v_mfma_f32_16x16x32_bf16 v[32:35], v[4:7], v[100:103], v[32:35]
  v_and_b32 v36, v26, v8
  v_and_b32 v37, v26, v9
  v_and_b32 v38, v26, v10
  v_and_b32 v39, v26, v11
  s_waitcnt vmcnt(5)
  s_nop 0
  v_mfma_f32_16x16x32_bf16 v[32:35], v[36:39], v[104:107], v[32:35]
  v_and_b32 v4, v27, v8
  v_and_b32 v5, v27, v9
  v_and_b32 v6, v27, v10
  v_and_b32 v7, v27, v11
  s_waitcnt vmcnt(4)
  s_nop 0
  v_mfma_f32_16x16x32_bf16 v[32:35], v[4:7], v[108:111], v[32:35]
  v_and_b32 v36, v28, v8
  v_and_b32 v37, v28, v9
  v_and_b32 v38, v28, v10
  v_and_b32 v39, v28, v11
  s_waitcnt vmcnt(3)
  s_nop 0
  v_mfma_f32_16x16x32_bf16 v[32:35], v[36:39], v[112:115], v[32:35]
  v_and_b32 v4, v29, v8
  v_and_b32 v5, v29, v9
  v_and_b32 v6, v29, v10
  v_and_b32 v7, v29, v11
  s_waitcnt vmcnt(2)
  s_nop 0
  v_mfma_f32_16x16x32_bf16 v[32:35], v[4:7], v[116:119], v[32:35]
  v_and_b32 v36, v30, v8
  v_and_b32 v37, v30, v9
  v_and_b32 v38, v30, v10
  v_and_b32 v39, v30, v11
  s_waitcnt vmcnt(1)
  s_nop 0
  v_mfma_f32_16x16x32_bf16 v[32:35], v[36:39], v[120:123], v[32:35]
  v_and_b32 v4, v31, v8
  v_and_b32 v5, v31, v9
  v_and_b32 v6, v31, v10
  v_and_b32 v7, v31, v11
  s_waitcnt vmcnt(0)
  s_nop 0
  v_mfma_f32_16x16x32_bf16 v[32:35], v[4:7], v[124:127], v[32:35]
  v_mov_b32 v8, 157976
  v_mov_b32 v9, 1
  s_nop 5
  ds_write_b128 v15, v[32:35]
  s_mov_b64 exec, 1
  ds_add_rtn_u32 v9, v8, v9
  s_mov_b64 exec, -1
  ds_read_b32 v10, v8 offset:24
  ds_read_b128 v[36:39], v59
  ds_read_b128 v[64:67], v14 offset:0
  ds_read_b128 v[68:71], v14 offset:1024
  ds_read_b128 v[72:75], v14 offset:2048
  ds_read_b128 v[76:79], v14 offset:3072
  ds_read_b128 v[80:83], v14 offset:4096
  ds_read_b128 v[84:87], v14 offset:5120
  ds_read_b128 v[88:91], v14 offset:6144
  ds_read_b128 v[92:95], v14 offset:7168
  s_waitcnt lgkmcnt(9)
  v_readfirstlane_b32 s47, v9
  v_readfirstlane_b32 s46, v10
  s_nop 0
  s_cmp_lg_u32 s47, 7
  s_cbranch_scc1 L_S_notlast
  global_load_dwordx4 v[96:99], v48, s[28:29] sc1
  global_load_dwordx4 v[100:103], v49, s[28:29] sc1
  global_load_dwordx4 v[104:107], v50, s[28:29] sc1
  s_waitcnt lgkmcnt(6)
  v_pk_add_f32 v[64:65], v[64:65], v[68:69]
  v_pk_add_f32 v[66:67], v[66:67], v[70:71]
  s_waitcnt lgkmcnt(4)
  v_pk_add_f32 v[72:73], v[72:73], v[76:77]
  v_pk_add_f32 v[74:75], v[74:75], v[78:79]
  v_pk_add_f32 v[64:65], v[64:65], v[72:73]
  v_pk_add_f32 v[66:67], v[66:67], v[74:75]
  s_waitcnt lgkmcnt(2)
  v_pk_add_f32 v[80:81], v[80:81], v[84:85]
  v_pk_add_f32 v[82:83], v[82:83], v[86:87]
  s_waitcnt lgkmcnt(0)
  v_pk_add_f32 v[88:89], v[88:89], v[92:93]
  v_pk_add_f32 v[90:91], v[90:91], v[94:95]
  v_pk_add_f32 v[80:81], v[80:81], v[88:89]
  v_pk_add_f32 v[82:83], v[82:83], v[90:91]
  v_pk_add_f32 v[64:65], v[64:65], v[80:81]
  v_pk_add_f32 v[66:67], v[66:67], v[82:83]
  s_cmp_eq_u32 s46, 2
  v_cvt_pk_bf16_f32 v40, v64, v65
  v_cvt_pk_bf16_f32 v42, v66, v67
  s_cbranch_scc1 L_opub_local
  global_store_dwordx4 v13, v[40:43], s[28:29] sc1
  s_branch L_opub_done
L_opub_local:
  global_store_dwordx4 v13, v[40:43], s[28:29]
L_opub_done:
  s_cmp_lg_u32 s46, 0
  s_cbranch_scc1 L_fok
  v_mov_b32 v10, 158000
LW_2:
  ds_read_b32 v11, v10
  s_add_u32 s62, s62, 1
  s_cmp_gt_u32 s62, 0x2000000
  s_cbranch_scc1 L_end
  s_waitcnt lgkmcnt(0)
  v_readfirstlane_b32 s46, v11
  s_nop 0
  s_cmp_lt_u32 s46, 1
  s_cbranch_scc1 LW_2
  ds_read_b128 v[36:39], v59
  s_waitcnt lgkmcnt(0)
L_fok:
  v_mul_f32 v64, v64, v36
  v_mul_f32 v65, v65, v36
  v_mul_f32 v66, v66, v36
  v_mul_f32 v67, v67, v36
  v_mov_b32 v9, 1
L_opoll:
  global_load_dwordx4 v[96:99], v48, s[28:29] sc1
  global_load_dwordx4 v[100:103], v49, s[28:29] sc1
  global_load_dwordx4 v[104:107], v50, s[28:29] sc1
  s_add_u32 s62, s62, 4
  s_cmp_gt_u32 s62, 0x2000000
  s_cbranch_scc1 L_end
  s_waitcnt vmcnt(3)
  v_xor_b32 v16, s60, v97
  v_xor_b32 v17, s61, v99
  v_or_b32 v16, v16, v17
  v_xor_b32 v17, s60, v101
  v_xor_b32 v18, s61, v103
  v_or3_b32 v16, v16, v17, v18
  v_xor_b32 v17, s60, v105
  v_xor_b32 v18, s61, v107
  v_or3_b32 v16, v16, v17, v18
  v_cmp_ne_u32 vcc, 0, v16
  s_cbranch_vccnz L_opoll
  v_lshlrev_b32 v16, 16, v96
  v_and_b32 v17, 0xffff0000, v96
  v_lshlrev_b32 v18, 16, v98
  v_and_b32 v19, 0xffff0000, v98
  v_fmac_f32 v64, v16, v37
  v_fmac_f32 v65, v17, v37
  v_fmac_f32 v66, v18, v37
  v_fmac_f32 v67, v19, v37
  v_lshlrev_b32 v16, 16, v100
  v_and_b32 v17, 0xffff0000, v100
  v_lshlrev_b32 v18, 16, v102
  v_and_b32 v19, 0xffff0000, v102
  v_fmac_f32 v64, v16, v38
  v_fmac_f32 v65, v17, v38
  v_fmac_f32 v66, v18, v38
  v_fmac_f32 v67, v19, v38
  v_lshlrev_b32 v16, 16, v104
  v_and_b32 v17, 0xffff0000, v104
  v_lshlrev_b32 v18, 16, v106
  v_and_b32 v19, 0xffff0000, v106
  v_fmac_f32 v64, v16, v39
  v_fmac_f32 v65, v17, v39
  v_fmac_f32 v66, v18, v39
  v_fmac_f32 v67, v19, v39
  v_cvt_pk_bf16_f32 v64, v64, v65
  v_cvt_pk_bf16_f32 v65, v66, v67
  ds_write_b64 v58, v[64:65]
  s_mov_b64 exec, 1
  ds_write_b32 v8, v9 offset:4
  s_mov_b64 exec, -1
  s_branch L_end
L_S_notlast:
  s_cmp_lt_u32 s47, 4
  s_cbranch_scc0 L_end
  s_add_u32 s56, s47, 4
  s_mov_b32 s57, 0
L_proj:
  s_setprio 0
  v_bfe_u32 v5, v0, 2, 2
  v_lshl_add_u32 v6, v2, 2, v5
  v_and_b32 v7, 3, v0
  v_lshlrev_b32 v7, 3, v7
  v_and_b32 v8, 7, v6
  v_xor_b32 v8, s56, v8
  v_lshl_add_u32 v8, v8, 5, v7
  v_lshl_add_u32 v50, v6, 8, v8
  v_bfe_u32 v8, v6, 1, 2
  v_xor_b32 v8, s3, v8
  v_and_b32 v8, 3, v8
  v_lshl_add_u32 v8, v8, 5, v7
  v_lshl_add_u32 v51, v6, 7, v8
  v_add_u32 v51, 65536, v51
  v_lshlrev_b32 v48, 4, v2
  v_add_u32 v48, 158464, v48
  s_mul_i32 s44, s32, 36
  s_lshl_b32 s45, s33, 3
  s_add_u32 s45, s45, s56
  s_add_u32 s45, s45, s44
  s_lshl_b32 s45, s45, 11
  s_add_u32 s44, s44, s3
  s_add_u32 s44, s44, 32
  s_lshl_b32 s44, s44, 11
  v_mov_b32 v6, s45
  v_mov_b32 v7, s44
  v_cmp_eq_u32 s[54:55], 1, v2
  v_and_b32 v8, 1, v0
  v_cmp_eq_u32 vcc, 1, v8
  v_cndmask_b32 v6, v6, v7, s[54:55]
  v_mov_b32 v61, s60
  v_mov_b32 v63, s61
  v_cndmask_b32 v61, v61, v63, vcc
  s_lshl_b32 s44, s30, 7
  s_add_u32 s44, s44, 1310720
  v_and_b32 v7, 15, v0
  v_lshl_add_u32 v6, v7, 3, v6
  v_add_u32 v54, s44, v6
  v_mov_b32 v4, 157972
LW_3:
  ds_read_b32 v5, v4
  s_add_u32 s62, s62, 1
  s_cmp_gt_u32 s62, 0x2000000
  s_cbranch_scc1 L_end
  s_sleep 1
  s_waitcnt lgkmcnt(0)
  v_readfirstlane_b32 s46, v5
  s_nop 0
  s_cmp_lt_u32 s46, 4
  s_cbranch_scc1 LW_3
  ds_read_b64_tr_b16 v[64:65], v50 offset:0
  ds_read_b64_tr_b16 v[66:67], v50 offset:4096
  ds_read_b64_tr_b16 v[68:69], v50 offset:8192
  ds_read_b64_tr_b16 v[70:71], v50 offset:12288
  ds_read_b64_tr_b16 v[72:73], v50 offset:16384
  ds_read_b64_tr_b16 v[74:75], v50 offset:20480
  ds_read_b64_tr_b16 v[76:77], v50 offset:24576
  ds_read_b64_tr_b16 v[78:79], v50 offset:28672
  s_waitcnt lgkmcnt(4)
  ds_read_b64_tr_b16 v[80:81], v50 offset:32768
  ds_read_b64_tr_b16 v[82:83], v50 offset:36864
  ds_read_b64_tr_b16 v[84:85], v50 offset:40960
  ds_read_b64_tr_b16 v[86:87], v50 offset:45056
  ds_read_b64_tr_b16 v[88:89], v50 offset:49152
  ds_read_b64_tr_b16 v[90:91], v50 offset:53248
  ds_read_b64_tr_b16 v[92:93], v50 offset:57344
  ds_read_b64_tr_b16 v[94:95], v50 offset:61440
  s_cmp_eq_u32 s57, 0
  s_cbranch_scc1 L_no8a
  s_waitcnt lgkmcnt(0)
  ds_read_b64_tr_b16 v[96:97], v51 offset:0
  ds_read_b64_tr_b16 v[98:99], v51 offset:2048
  ds_read_b64_tr_b16 v[100:101], v51 offset:4096
  ds_read_b64_tr_b16 v[102:103], v51 offset:6144
  ds_read_b64_tr_b16 v[104:105], v51 offset:8192
  ds_read_b64_tr_b16 v[106:107], v51 offset:10240
  ds_read_b64_tr_b16 v[108:109], v51 offset:12288
  ds_read_b64_tr_b16 v[110:111], v51 offset:14336
  s_waitcnt lgkmcnt(4)
  ds_read_b64_tr_b16 v[112:113], v51 offset:16384
  ds_read_b64_tr_b16 v[114:115], v51 offset:18432
  ds_read_b64_tr_b16 v[116:117], v51 offset:20480
  ds_read_b64_tr_b16 v[118:119], v51 offset:22528
  ds_read_b64_tr_b16 v[120:121], v51 offset:24576
  ds_read_b64_tr_b16 v[122:123], v51 offset:26624
  ds_read_b64_tr_b16 v[124:125], v51 offset:28672
  ds_read_b64_tr_b16 v[126:127], v51 offset:30720
L_no8a:
  s_waitcnt lgkmcnt(0)
  v_mov_b32 v6, 157976
LW_4:
  ds_read_b32 v7, v6
  s_add_u32 s62, s62, 1
  s_cmp_gt_u32 s62, 0x2000000
  s_cbranch_scc1 L_end
  s_sleep 1
  s_waitcnt lgkmcnt(0)
  v_readfirstlane_b32 s46, v7
  s_nop 0
  s_cmp_lt_u32 s46, 8
  s_cbranch_scc1 LW_4
  v_mov_b32 v4, 157980
L_obwait:
  ds_read_b32 v5, v4
  ds_read_b128 v[16:19], v48
  ds_read_b128 v[20:23], v48 offset:64
  s_add_u32 s62, s62, 1
  s_cmp_gt_u32 s62, 0x2000000
  s_cbranch_scc1 L_end
  s_waitcnt lgkmcnt(2)
  v_readfirstlane_b32 s46, v5
  s_nop 0
  s_cmp_eq_u32 s46, 0
  s_cbranch_scc1 L_obwait
  ds_read_b128 v[24:27], v48 offset:128
  ds_read_b128 v[28:31], v48 offset:192
  ds_read_b128 v[32:35], v48 offset:256
  ds_read_b128 v[36:39], v48 offset:320
  ds_read_b128 v[40:43], v48 offset:384
  ds_read_b128 v[44:47], v48 offset:448
  s_cmp_eq_u32 s57, 0
  s_cbranch_scc0 L_proj2
  s_waitcnt lgkmcnt(6)
  v_mfma_f32_16x16x32_bf16 v[8:11], v[16:19], v[64:67], 0
  s_waitcnt lgkmcnt(6)
  v_mfma_f32_16x16x32_bf16 v[8:11], v[20:23], v[68:71], v[8:11]
  s_waitcnt lgkmcnt(5)
  v_mfma_f32_16x16x32_bf16 v[8:11], v[24:27], v[72:75], v[8:11]
  s_waitcnt lgkmcnt(4)
  v_mfma_f32_16x16x32_bf16 v[8:11], v[28:31], v[76:79], v[8:11]
  s_waitcnt lgkmcnt(3)
  v_mfma_f32_16x16x32_bf16 v[8:11], v[32:35], v[80:83], v[8:11]
  s_waitcnt lgkmcnt(2)
  v_mfma_f32_16x16x32_bf16 v[8:11], v[36:39], v[84:87], v[8:11]
  s_waitcnt lgkmcnt(1)
  v_mfma_f32_16x16x32_bf16 v[8:11], v[40:43], v[88:91], v[8:11]
  s_waitcnt lgkmcnt(0)
  v_mfma_f32_16x16x32_bf16 v[8:11], v[44:47], v[92:95], v[8:11]
  s_mov_b64 exec, 0xffff
  s_nop 6
  v_mov_b32 v60, v8
  global_store_dwordx2 v54, v[60:61], s[28:29] sc1
  s_mov_b64 exec, -1
  s_branch L_end
L_proj2:
  s_waitcnt lgkmcnt(6)
  v_mfma_f32_16x16x32_bf16 v[8:11], v[16:19], v[64:67], 0
  v_mfma_f32_16x16x32_bf16 v[12:15], v[16:19], v[96:99], 0
  s_waitcnt lgkmcnt(6)
  v_mfma_f32_16x16x32_bf16 v[8:11], v[20:23], v[68:71], v[8:11]
  v_mfma_f32_16x16x32_bf16 v[12:15], v[20:23], v[100:103], v[12:15]
  s_waitcnt lgkmcnt(5)
  v_mfma_f32_16x16x32_bf16 v[8:11], v[24:27], v[72:75], v[8:11]
  v_mfma_f32_16x16x32_bf16 v[12:15], v[24:27], v[104:107], v[12:15]
  s_waitcnt lgkmcnt(4)
  v_mfma_f32_16x16x32_bf16 v[8:11], v[28:31], v[76:79], v[8:11]
  v_mfma_f32_16x16x32_bf16 v[12:15], v[28:31], v[108:111], v[12:15]
  s_waitcnt lgkmcnt(3)
  v_mfma_f32_16x16x32_bf16 v[8:11], v[32:35], v[80:83], v[8:11]
  v_mfma_f32_16x16x32_bf16 v[12:15], v[32:35], v[112:115], v[12:15]
  s_waitcnt lgkmcnt(2)
  v_mfma_f32_16x16x32_bf16 v[8:11], v[36:39], v[84:87], v[8:11]
  v_mfma_f32_16x16x32_bf16 v[12:15], v[36:39], v[116:119], v[12:15]
  s_waitcnt lgkmcnt(1)
  v_mfma_f32_16x16x32_bf16 v[8:11], v[40:43], v[88:91], v[8:11]
  v_mfma_f32_16x16x32_bf16 v[12:15], v[40:43], v[120:123], v[12:15]
  s_waitcnt lgkmcnt(0)
  v_mfma_f32_16x16x32_bf16 v[8:11], v[44:47], v[92:95], v[8:11]
  v_mfma_f32_16x16x32_bf16 v[12:15], v[44:47], v[124:127], v[12:15]
  s_mov_b32 exec_hi, 0
  s_nop 6
  v_cndmask_b32 v60, v8, v12, s[54:55]
  global_store_dwordx2 v54, v[60:61], s[28:29] sc1
  s_mov_b64 exec, -1
  s_branch L_end
L_A:
  s_getreg_b32 s63, hwreg(HW_REG_XCC_ID, 0, 4)
  s_waitcnt lgkmcnt(0)
  s_add_u32 s60, s60, 0x7f4a7c15
  s_addc_u32 s61, s61, 0x9e3779b9
  s_lshl_b32 s45, s30, 6
  s_lshl_b32 s46, s31, 2
  s_add_u32 s46, s46, s45
  s_add_u32 s45, s45, 2048
  s_add_u32 s48, s28, s45
  s_addc_u32 s49, s29, 0
  s_xor_b32 s47, s61, s63
  s_cmp_lg_u32 s3, 1
  s_cbranch_scc1 L_A_noid
  v_mov_b32 v4, s46
  v_mov_b32 v5, s47
  s_mov_b64 exec, 1
  global_store_dword v4, v5, s[28:29] offset:2048
  s_mov_b64 exec, -1
L_A_noid:
  s_add_u32 s44, s44, 149504
  v_add_u32 v11, s44, v1
  v_add_u32 v12, s44, v14
  s_cmp_lg_u32 s3, 1
  s_cbranch_scc1 L_A_w0
  s_waitcnt vmcnt(1)
  s_branch L_A_w1
L_A_w0:
  s_waitcnt vmcnt(0)
L_A_w1:
  v_lshlrev_b32 v22, 16, v16
  v_and_b32 v23, 0xffff0000, v16
  v_lshlrev_b32 v24, 16, v17
  v_and_b32 v25, 0xffff0000, v17
  v_lshlrev_b32 v26, 16, v18
  v_and_b32 v27, 0xffff0000, v18
  v_lshlrev_b32 v28, 16, v19
  v_and_b32 v29, 0xffff0000, v19
  v_lshlrev_b32 v30, 16, v20
  s_call_b64 s[50:51], L_ln
  v_cvt_pk_bf16_f32 v16, v22, v23
  v_cvt_pk_bf16_f32 v17, v24, v25
  v_cvt_pk_bf16_f32 v18, v26, v27
  v_cvt_pk_bf16_f32 v19, v28, v29
  v_lshrrev_b32 v20, 16, v30
  ds_write_b128 v11, v[16:19]
  ds_write_b16 v12, v20 offset:1024
  s_cmp_lg_u32 s3, 0
  s_cbranch_scc1 L_A_notag
  v_mov_b32 v11, 158016
  v_mov_b32 v12, s60
  v_mov_b32 v13, s61
  ds_write_b64 v11, v[12:13]
L_A_notag:
  v_mov_b32 v4, 157952
  v_mov_b32 v5, 1
  s_mov_b64 exec, 1
  ds_add_u32 v4, v5
  s_mov_b64 exec, -1
  s_cmp_lg_u32 s3, 1
  s_cbranch_scc1 L_A_noidchk
  v_lshlrev_b32 v4, 2, v0
  s_mov_b32 s45, 0
  s_mov_b64 exec, 0xffff
L_idpoll:
  global_load_dword v5, v4, s[48:49] sc1
  s_add_u32 s45, s45, 1
  s_waitcnt vmcnt(0)
  v_cmp_ne_u32 vcc, s47, v5
  s_mov_b32 s44, 2
  s_cbranch_vccz L_iddone
  s_mov_b32 s44, 1
  s_cmp_lt_u32 s45, 4
  s_cbranch_scc1 L_idpoll
L_iddone:
  s_mov_b64 exec, -1
  v_mov_b32 v4, 158004
  v_mov_b32 v5, s44
  ds_write_b32 v4, v5
L_A_noidchk:
  s_cmp_lg_u32 s3, 0
  s_cbranch_scc1 L_A_poll
  v_bfe_u32 v3, v0, 2, 2
  v_lshl_add_u32 v4, v2, 2, v3
  v_bfe_u32 v5, v4, 1, 2
  v_lshlrev_b32 v5, 5, v5
  v_lshl_add_u32 v5, v4, 7, v5
  v_and_b32 v6, 3, v0
  v_lshl_add_u32 v5, v6, 3, v5
  v_add_u32 v8, 131072, v5
  v_xor_b32 v9, 32, v8
  v_xor_b32 v10, 64, v8
  v_xor_b32 v11, 0x60, v8
  v_mul_u32_u24 v12, 1152, v3
  v_lshl_add_u32 v12, v2, 3, v12
  s_mul_i32 s44, s32, 288
  s_add_u32 s44, s44, 149504
  v_add_u32 v12, s44, v12
  s_lshl_b32 s44, s30, 15
  s_lshl_b32 s45, s32, 11
  s_add_u32 s44, s44, s45
  s_lshl_b32 s45, s33, 9
  s_add_u32 s44, s44, s45
  s_add_u32 s44, s44, 4096
  v_lshlrev_b32 v13, 13, v2
  v_and_b32 v4, 15, v0
  v_lshl_add_u32 v13, v4, 4, v13
  v_add_u32 v13, s44, v13
  v_mov_b32 v53, s60
  v_mov_b32 v55, s61
  v_mov_b32 v4, 157952
LW_5:
  ds_read_b32 v5, v4
  s_add_u32 s62, s62, 1
  s_cmp_gt_u32 s62, 0x2000000
  s_cbranch_scc1 L_end
  s_waitcnt lgkmcnt(0)
  v_readfirstlane_b32 s46, v5
  s_nop 0
  s_cmp_lt_u32 s46, 4
  s_cbranch_scc1 LW_5
  ds_read2_b64 v[16:19], v12 offset0:0 offset1:4
  ds_read2_b64 v[20:23], v12 offset0:8 offset1:12
  ds_read2_b64 v[24:27], v12 offset0:16 offset1:20
  ds_read2_b64 v[28:31], v12 offset0:24 offset1:28
  ds_read_b64 v[32:33], v12 offset:256
  v_mov_b32 v5, s60
  v_mov_b32 v7, s61
  v_mov_b32 v14, 157992
LW_6:
  ds_read_b32 v15, v14
  s_add_u32 s62, s62, 1
  s_cmp_gt_u32 s62, 0x2000000
  s_cbranch_scc1 L_end
  s_waitcnt lgkmcnt(0)
  v_readfirstlane_b32 s46, v15
  s_nop 0
  s_cmp_lt_u32 s46, 8
  s_cbranch_scc1 LW_6
  ds_read_b64_tr_b16 v[56:57], v8 offset:0
  ds_read_b64_tr_b16 v[58:59], v8 offset:2048
  ds_read_b64_tr_b16 v[60:61], v8 offset:4096
  ds_read_b64_tr_b16 v[62:63], v8 offset:6144
  ds_read_b64_tr_b16 v[64:65], v8 offset:8192
  ds_read_b64_tr_b16 v[66:67], v8 offset:10240
  ds_read_b64_tr_b16 v[68:69], v8 offset:12288
  ds_read_b64_tr_b16 v[70:71], v8 offset:14336
  ds_read_b64_tr_b16 v[72:73], v8 offset:16384
  ds_read_b64_tr_b16 v[74:75], v9 offset:0
  ds_read_b64_tr_b16 v[76:77], v9 offset:2048
  ds_read_b64_tr_b16 v[78:79], v9 offset:4096
  ds_read_b64_tr_b16 v[80:81], v9 offset:6144
  ds_read_b64_tr_b16 v[82:83], v9 offset:8192
  s_waitcnt lgkmcnt(5)
  v_mfma_f32_16x16x16_bf16 v[36:39], v[32:33], v[72:73], 0
  s_nop 5
  v_mfma_f32_16x16x32_bf16 v[36:39], v[16:19], v[56:59], v[36:39]
  v_mfma_f32_16x16x32_bf16 v[36:39], v[20:23], v[60:63], v[36:39]
  v_mfma_f32_16x16x32_bf16 v[36:39], v[24:27], v[64:67], v[36:39]
  v_mfma_f32_16x16x32_bf16 v[36:39], v[28:31], v[68:71], v[36:39]
  ds_read_b64_tr_b16 v[84:85], v9 offset:10240
  ds_read_b64_tr_b16 v[86:87], v9 offset:12288
  ds_read_b64_tr_b16 v[88:89], v9 offset:14336
  ds_read_b64_tr_b16 v[90:91], v9 offset:16384
  ds_read_b64_tr_b16 v[92:93], v10 offset:0
  ds_read_b64_tr_b16 v[94:95], v10 offset:2048
  ds_read_b64_tr_b16 v[96:97], v10 offset:4096
  ds_read_b64_tr_b16 v[98:99], v10 offset:6144
  ds_read_b64_tr_b16 v[100:101], v10 offset:8192
  s_waitcnt lgkmcnt(5)
  v_mfma_f32_16x16x16_bf16 v[40:43], v[32:33], v[90:91], 0
  s_nop 5
  v_mfma_f32_16x16x32_bf16 v[40:43], v[16:19], v[74:77], v[40:43]
  v_mfma_f32_16x16x32_bf16 v[40:43], v[20:23], v[78:81], v[40:43]
  v_mfma_f32_16x16x32_bf16 v[40:43], v[24:27], v[82:85], v[40:43]
  v_mfma_f32_16x16x32_bf16 v[40:43], v[28:31], v[86:89], v[40:43]
  ds_read_b64_tr_b16 v[102:103], v10 offset:10240
  ds_read_b64_tr_b16 v[104:105], v10 offset:12288
  ds_read_b64_tr_b16 v[106:107], v10 offset:14336
  ds_read_b64_tr_b16 v[108:109], v10 offset:16384
  ds_read_b64_tr_b16 v[110:111], v11 offset:0
  ds_read_b64_tr_b16 v[112:113], v11 offset:2048
  ds_read_b64_tr_b16 v[114:115], v11 offset:4096
  ds_read_b64_tr_b16 v[116:117], v11 offset:6144
  ds_read_b64_tr_b16 v[118:119], v11 offset:8192
  s_waitcnt lgkmcnt(5)
  v_mfma_f32_16x16x16_bf16 v[44:47], v[32:33], v[108:109], 0
  s_nop 5
  v_mfma_f32_16x16x32_bf16 v[44:47], v[16:19], v[92:95], v[44:47]
  v_mfma_f32_16x16x32_bf16 v[44:47], v[20:23], v[96:99], v[44:47]
  v_mfma_f32_16x16x32_bf16 v[44:47], v[24:27], v[100:103], v[44:47]
  v_mfma_f32_16x16x32_bf16 v[44:47], v[28:31], v[104:107], v[44:47]
  ds_read_b64_tr_b16 v[120:121], v11 offset:10240
  ds_read_b64_tr_b16 v[122:123], v11 offset:12288
  ds_read_b64_tr_b16 v[124:125], v11 offset:14336
  ds_read_b64_tr_b16 v[126:127], v11 offset:16384
  s_waitcnt lgkmcnt(0)
  v_mfma_f32_16x16x16_bf16 v[48:51], v[32:33], v[126:127], 0
  s_nop 5
  v_mfma_f32_16x16x32_bf16 v[48:51], v[16:19], v[110:113], v[48:51]
  v_mfma_f32_16x16x32_bf16 v[48:51], v[20:23], v[114:117], v[48:51]
  v_mfma_f32_16x16x32_bf16 v[48:51], v[24:27], v[118:121], v[48:51]
  v_mfma_f32_16x16x32_bf16 v[48:51], v[28:31], v[122:125], v[48:51]
  v_mov_b32 v14, 158004
LW_7:
  ds_read_b32 v15, v14
  s_add_u32 s62, s62, 1
  s_cmp_gt_u32 s62, 0x2000000
  s_cbranch_scc1 L_end
  s_waitcnt lgkmcnt(0)
  v_readfirstlane_b32 s46, v15
  s_nop 0
  s_cmp_lt_u32 s46, 1
  s_cbranch_scc1 LW_7
  v_mov_b32 v4, v36
  v_mov_b32 v6, v40
  v_mov_b32 v52, v44
  v_mov_b32 v54, v48
  s_cmp_eq_u32 s46, 2
  s_cbranch_scc1 L_qpub_local
  global_store_dwordx4 v13, v[4:7], s[28:29] sc1
  global_store_dwordx4 v13, v[52:55], s[28:29] offset:256 sc1
  s_branch L_qpub_done
L_qpub_local:
  global_store_dwordx4 v13, v[4:7], s[28:29]
  global_store_dwordx4 v13, v[52:55], s[28:29] offset:256
L_qpub_done:
  v_mov_b32 v8, 157996
  v_mov_b32 v9, 1
  s_mov_b64 exec, 1
  ds_add_u32 v8, v9
  s_mov_b64 exec, -1
L_A_poll:
  s_lshl_b32 s44, s30, 15
  s_lshl_b32 s45, s32, 13
  s_add_u32 s44, s44, s45
  s_lshl_b32 s45, s3, 9
  s_add_u32 s44, s44, s45
  s_add_u32 s44, s44, 4096
  s_add_u32 s48, s28, s44
  s_addc_u32 s49, s29, 0
  v_lshrrev_b32 v20, 5, v0
  v_and_b32 v3, 31, v0
  v_lshlrev_b32 v21, 12, v20
  v_lshl_add_u32 v21, v3, 4, v21
  v_add_u32 v21, s44, v21
  s_lshl_b32 s44, s3, 7
  s_add_u32 s44, s44, 156416
  v_and_b32 v3, 15, v0
  v_lshlrev_b32 v22, 1, v3
  v_lshl_add_u32 v22, v20, 5, v22
  v_bfe_u32 v23, v0, 4, 1
  v_lshl_add_u32 v22, v23, 6, v22
  v_add_u32 v22, s44, v22
  v_bfe_u32 v24, v0, 3, 1
  v_lshlrev_b32 v24, 8, v24
  v_lshl_add_u32 v24, v2, 4, v24
  v_add_u32 v24, 156416, v24
  v_and_b32 v25, 3, v0
  v_bfe_u32 v26, v0, 2, 2
  v_lshl_add_u32 v25, v25, 2, v26
  v_lshlrev_b32 v25, 8, v25
  v_xor_b32 v26, v2, v3
  v_lshl_add_u32 v25, v26, 4, v25
  s_lshl_b32 s44, s3, 15
  v_add_u32 v28, s44, v25
  v_xor_b32 v29, 64, v28
  v_xor_b32 v30, 0x80, v28
  v_xor_b32 v31, 0xc0, v28
  v_mov_b32 v8, 157996
LW_8:
  ds_read_b32 v9, v8
  s_add_u32 s62, s62, 1
  s_cmp_gt_u32 s62, 0x2000000
  s_cbranch_scc1 L_end
  s_sleep 2
  s_waitcnt lgkmcnt(0)
  v_readfirstlane_b32 s46, v9
  s_nop 0
  s_cmp_lt_u32 s46, 1
  s_cbranch_scc1 LW_8
  ds_read_b32 v9, v8 offset:8
  s_waitcnt lgkmcnt(0)
  v_readfirstlane_b32 s46, v9
  s_nop 0
  s_cmp_eq_u32 s46, 2
  s_cbranch_scc1 L_qpoll
L_qsp:
  s_load_dwordx2 s[52:53], s[48:49], 0x1f8 glc
  s_load_dwordx2 s[54:55], s[48:49], 0x9f8 glc
  s_load_dwordx2 s[56:57], s[48:49], 0x11f8 glc
  s_load_dwordx2 s[58:59], s[48:49], 0x19f8 glc
  s_add_u32 s62, s62, 4
  s_cmp_gt_u32 s62, 0x2000000
  s_cbranch_scc1 L_end
  s_sleep 2
  s_waitcnt lgkmcnt(0)
  s_xor_b32 s53, s53, s61
  s_xor_b32 s55, s55, s61
  s_xor_b32 s57, s57, s61
  s_xor_b32 s59, s59, s61
  s_or_b32 s53, s53, s55
  s_or_b32 s57, s57, s59
  s_or_b32 s53, s53, s57
  s_cbranch_scc1 L_qsp
L_qpoll:
  global_load_dwordx4 v[8:11], v21, s[28:29] sc1
  global_load_dwordx4 v[12:15], v21, s[28:29] offset:2048 sc1
  s_add_u32 s62, s62, 4
  s_cmp_gt_u32 s62, 0x2000000
  s_cbranch_scc1 L_end
  s_waitcnt vmcnt(0)
  v_xor_b32 v16, s60, v9
  v_xor_b32 v17, s61, v11
  v_or_b32 v16, v16, v17
  v_xor_b32 v17, s60, v13
  v_xor_b32 v18, s61, v15
  v_or3_b32 v16, v16, v17, v18
  v_cmp_ne_u32 vcc, 0, v16
  s_cbranch_vccnz L_qpoll
L_qskip:
  s_mov_b64 exec, -1
  v_add_f32 v8, v8, v12
  v_add_f32 v10, v10, v14
  s_nop 1
  v_permlane32_swap_b32 v8, v10
  v_add_f32 v8, v8, v10
  v_cvt_pk_bf16_f32 v8, v8, v8
  ds_write_b16 v22, v8
  v_mov_b32 v6, 157956
  v_mov_b32 v7, 1
  s_mov_b64 exec, 1
  ds_add_u32 v6, v7
  s_mov_b64 exec, -1
  v_mov_b32 v6, 157956
LW_9:
  ds_read_b32 v7, v6
  s_add_u32 s62, s62, 1
  s_cmp_gt_u32 s62, 0x2000000
  s_cbranch_scc1 L_end
  s_waitcnt lgkmcnt(0)
  v_readfirstlane_b32 s46, v7
  s_nop 0
  s_cmp_lt_u32 s46, 4
  s_cbranch_scc1 LW_9
  ds_read_b128 v[8:11], v24 offset:0
  ds_read_b128 v[12:15], v24 offset:64
  ds_read_b128 v[16:19], v24 offset:128
  ds_read_b128 v[20:23], v24 offset:192
  v_mov_b32 v6, 157960
LW_10:
  ds_read_b32 v7, v6
  s_add_u32 s62, s62, 1
  s_cmp_gt_u32 s62, 0x2000000
  s_cbranch_scc1 L_end
  s_sleep 1
  s_waitcnt lgkmcnt(0)
  v_readfirstlane_b32 s46, v7
  s_nop 0
  s_cmp_lt_u32 s46, 8
  s_cbranch_scc1 LW_10
  ds_read_b128 v[64:67], v28 offset:0
  ds_read_b128 v[68:71], v29 offset:0
  ds_read_b128 v[72:75], v30 offset:0
  ds_read_b128 v[76:79], v31 offset:0
  ds_read_b128 v[80:83], v28 offset:4096
  ds_read_b128 v[84:87], v29 offset:4096
  ds_read_b128 v[88:91], v30 offset:4096
  ds_read_b128 v[92:95], v31 offset:4096
  ds_read_b128 v[96:99], v28 offset:8192
  ds_read_b128 v[100:103], v29 offset:8192
  ds_read_b128 v[104:107], v30 offset:8192
  ds_read_b128 v[108:111], v31 offset:8192
  s_waitcnt lgkmcnt(11)
  v_mfma_f32_16x16x32_bf16 v[32:35], v[64:67], v[8:11], 0
  s_waitcnt lgkmcnt(10)
  v_mfma_f32_16x16x32_bf16 v[32:35], v[68:71], v[12:15], v[32:35]
  s_waitcnt lgkmcnt(9)
  v_mfma_f32_16x16x32_bf16 v[32:35], v[72:75], v[16:19], v[32:35]
  s_waitcnt lgkmcnt(8)
  v_mfma_f32_16x16x32_bf16 v[32:35], v[76:79], v[20:23], v[32:35]
  ds_read_b128 v[112:115], v28 offset:12288
  ds_read_b128 v[116:119], v29 offset:12288
  ds_read_b128 v[120:123], v30 offset:12288
  ds_read_b128 v[124:127], v31 offset:12288
  s_waitcnt lgkmcnt(11)
  v_mfma_f32_16x16x32_bf16 v[36:39], v[80:83], v[8:11], 0
  s_waitcnt lgkmcnt(10)
  v_mfma_f32_16x16x32_bf16 v[36:39], v[84:87], v[12:15], v[36:39]
  s_waitcnt lgkmcnt(9)
  v_mfma_f32_16x16x32_bf16 v[36:39], v[88:91], v[16:19], v[36:39]
  s_waitcnt lgkmcnt(8)
  v_mfma_f32_16x16x32_bf16 v[36:39], v[92:95], v[20:23], v[36:39]
  ds_read_b128 v[64:67], v28 offset:16384
  ds_read_b128 v[68:71], v29 offset:16384
  ds_read_b128 v[72:75], v30 offset:16384
  ds_read_b128 v[76:79], v31 offset:16384
  s_waitcnt lgkmcnt(11)
  v_mfma_f32_16x16x32_bf16 v[40:43], v[96:99], v[8:11], 0
  s_waitcnt lgkmcnt(10)
  v_mfma_f32_16x16x32_bf16 v[40:43], v[100:103], v[12:15], v[40:43]
  s_waitcnt lgkmcnt(9)
  v_mfma_f32_16x16x32_bf16 v[40:43], v[104:107], v[16:19], v[40:43]
  s_waitcnt lgkmcnt(8)
  v_mfma_f32_16x16x32_bf16 v[40:43], v[108:111], v[20:23], v[40:43]
  ds_read_b128 v[80:83], v28 offset:20480
  ds_read_b128 v[84:87], v29 offset:20480
  ds_read_b128 v[88:91], v30 offset:20480
  ds_read_b128 v[92:95], v31 offset:20480
  s_waitcnt lgkmcnt(11)
  v_mfma_f32_16x16x32_bf16 v[44:47], v[112:115], v[8:11], 0
  s_waitcnt lgkmcnt(10)
  v_mfma_f32_16x16x32_bf16 v[44:47], v[116:119], v[12:15], v[44:47]
  s_waitcnt lgkmcnt(9)
  v_mfma_f32_16x16x32_bf16 v[44:47], v[120:123], v[16:19], v[44:47]
  s_waitcnt lgkmcnt(8)
  v_mfma_f32_16x16x32_bf16 v[44:47], v[124:127], v[20:23], v[44:47]
  ds_read_b128 v[96:99], v28 offset:24576
  ds_read_b128 v[100:103], v29 offset:24576
  ds_read_b128 v[104:107], v30 offset:24576
  ds_read_b128 v[108:111], v31 offset:24576
  s_waitcnt lgkmcnt(11)
  v_mfma_f32_16x16x32_bf16 v[48:51], v[64:67], v[8:11], 0
  s_waitcnt lgkmcnt(10)
  v_mfma_f32_16x16x32_bf16 v[48:51], v[68:71], v[12:15], v[48:51]
  s_waitcnt lgkmcnt(9)
  v_mfma_f32_16x16x32_bf16 v[48:51], v[72:75], v[16:19], v[48:51]
  s_waitcnt lgkmcnt(8)
  v_mfma_f32_16x16x32_bf16 v[48:51], v[76:79], v[20:23], v[48:51]
  ds_read_b128 v[112:115], v28 offset:28672
  ds_read_b128 v[116:119], v29 offset:28672
  ds_read_b128 v[120:123], v30 offset:28672
  ds_read_b128 v[124:127], v31 offset:28672
  s_waitcnt lgkmcnt(11)
  v_mfma_f32_16x16x32_bf16 v[52:55], v[80:83], v[8:11], 0
  s_waitcnt lgkmcnt(10)
  v_mfma_f32_16x16x32_bf16 v[52:55], v[84:87], v[12:15], v[52:55]
  s_waitcnt lgkmcnt(9)
  v_mfma_f32_16x16x32_bf16 v[52:55], v[88:91], v[16:19], v[52:55]
  s_waitcnt lgkmcnt(8)
  v_mfma_f32_16x16x32_bf16 v[52:55], v[92:95], v[20:23], v[52:55]
  s_waitcnt lgkmcnt(7)
  v_mfma_f32_16x16x32_bf16 v[56:59], v[96:99], v[8:11], 0
  s_waitcnt lgkmcnt(6)
  v_mfma_f32_16x16x32_bf16 v[56:59], v[100:103], v[12:15], v[56:59]
  s_waitcnt lgkmcnt(5)
  v_mfma_f32_16x16x32_bf16 v[56:59], v[104:107], v[16:19], v[56:59]
  s_waitcnt lgkmcnt(4)
  v_mfma_f32_16x16x32_bf16 v[56:59], v[108:111], v[20:23], v[56:59]
  s_waitcnt lgkmcnt(3)
  v_mfma_f32_16x16x32_bf16 v[60:63], v[112:115], v[8:11], 0
  s_waitcnt lgkmcnt(2)
  v_mfma_f32_16x16x32_bf16 v[60:63], v[116:119], v[12:15], v[60:63]
  s_waitcnt lgkmcnt(1)
  v_mfma_f32_16x16x32_bf16 v[60:63], v[120:123], v[16:19], v[60:63]
  s_waitcnt lgkmcnt(0)
  v_mfma_f32_16x16x32_bf16 v[60:63], v[124:127], v[20:23], v[60:63]
  s_mov_b32 s44, 0x02020202
  s_mov_b32 exec_lo, s44
  s_mov_b32 exec_hi, s44
  v_mov_b32 v32, v36
  v_mov_b32 v33, v37
  v_mov_b32 v34, v38
  v_mov_b32 v35, v39
  s_lshl_b32 s44, s44, 1
  s_mov_b32 exec_lo, s44
  s_mov_b32 exec_hi, s44
  v_mov_b32 v32, v40
  v_mov_b32 v33, v41
  v_mov_b32 v34, v42
  v_mov_b32 v35, v43
  s_lshl_b32 s44, s44, 1
  s_mov_b32 exec_lo, s44
  s_mov_b32 exec_hi, s44
  v_mov_b32 v32, v44
  v_mov_b32 v33, v45
  v_mov_b32 v34, v46
  v_mov_b32 v35, v47
  s_lshl_b32 s44, s44, 1
  s_mov_b32 exec_lo, s44
  s_mov_b32 exec_hi, s44
  v_mov_b32 v32, v48
  v_mov_b32 v33, v49
  v_mov_b32 v34, v50
  v_mov_b32 v35, v51
  s_lshl_b32 s44, s44, 1
  s_mov_b32 exec_lo, s44
  s_mov_b32 exec_hi, s44
  v_mov_b32 v32, v52
  v_mov_b32 v33, v53
  v_mov_b32 v34, v54
  v_mov_b32 v35, v55
  s_lshl_b32 s44, s44, 1
  s_mov_b32 exec_lo, s44
  s_mov_b32 exec_hi, s44
  v_mov_b32 v32, v56
  v_mov_b32 v33, v57
  v_mov_b32 v34, v58
  v_mov_b32 v35, v59
  s_lshl_b32 s44, s44, 1
  s_mov_b32 exec_lo, s44
  s_mov_b32 exec_hi, s44
  v_mov_b32 v32, v60
  v_mov_b32 v33, v61
  v_mov_b32 v34, v62
  v_mov_b32 v35, v63
  s_lshl_b32 s44, s44, 1
  s_mov_b64 exec, -1
  v_mov_b32 v20, 0x3db504f3
  v_cvt_pk_bf16_f32 v33, v32, v33
  v_lshlrev_b32 v32, 16, v33
  v_and_b32 v33, 0xffff0000, v33
  v_mul_f32 v32, v32, v20
  v_mul_f32 v33, v33, v20
  v_cvt_pk_bf16_f32 v33, v32, v33
  v_lshlrev_b32 v32, 16, v33
  v_and_b32 v33, 0xffff0000, v33
  v_cvt_pk_bf16_f32 v35, v34, v35
  v_lshlrev_b32 v34, 16, v35
  v_and_b32 v35, 0xffff0000, v35
  v_mul_f32 v34, v34, v20
  v_mul_f32 v35, v35, v20
  v_cvt_pk_bf16_f32 v35, v34, v35
  v_lshlrev_b32 v34, 16, v35
  v_and_b32 v35, 0xffff0000, v35
  v_max_f32 v3, v32, v33
  v_max3_f32 v3, v3, v34, v35
  v_bfe_u32 v5, v0, 3, 1
  v_lshlrev_b32 v5, 4, v5
  v_max_f32_dpp v3, v3, v3 quad_perm:[1,0,3,2] row_mask:0xf bank_mask:0xf
  v_add_u32 v5, 158048, v5
  s_lshl_b32 s44, s3, 2
  v_max_f32_dpp v3, v3, v3 quad_perm:[2,3,0,1] row_mask:0xf bank_mask:0xf
  v_add_u32 v6, s44, v5
  s_nop 0
  v_max_f32_dpp v3, v3, v3 row_half_mirror row_mask:0xf bank_mask:0xf
  v_mov_b32 v4, v3
  s_nop 1
  v_permlane32_swap_b32 v3, v4
  v_max_f32 v3, v3, v4
  v_mov_b32 v4, v3
  s_nop 1
  v_permlane16_swap_b32 v3, v4
  v_max_f32 v3, v3, v4
  ds_write_b32 v6, v3
  v_mov_b32 v8, 157964
  v_mov_b32 v9, 1
  s_mov_b64 exec, 1
  ds_add_u32 v8, v9
  s_mov_b64 exec, -1
  v_bfe_u32 v7, v0, 3, 1
  v_lshlrev_b32 v7, 11, v7
  v_lshl_add_u32 v7, v2, 6, v7
  v_bfe_u32 v8, v0, 2, 1
  v_lshl_add_u32 v7, v8, 8, v7
  v_and_b32 v8, 3, v0
  v_lshl_add_u32 v7, v8, 4, v7
  s_lshl_b32 s44, s3, 9
  s_add_u32 s44, s44, 131072
  v_add_u32 v14, s44, v7
  v_mov_b32 v8, 157964
LW_11:
  ds_read_b32 v9, v8
  s_add_u32 s62, s62, 1
  s_cmp_gt_u32 s62, 0x2000000
  s_cbranch_scc1 L_end
  s_waitcnt lgkmcnt(0)
  v_readfirstlane_b32 s46, v9
  s_nop 0
  s_cmp_lt_u32 s46, 4
  s_cbranch_scc1 LW_11
  ds_read_b128 v[8:11], v5
  v_mov_b32 v20, 0x3fb8aa3b
  s_waitcnt lgkmcnt(0)
  v_max_f32 v3, v8, v9
  v_max3_f32 v3, v3, v10, v11
  v_mul_f32 v4, v3, v20
  v_fma_f32 v32, v32, v20, -v4
  v_fma_f32 v33, v33, v20, -v4
  v_fma_f32 v34, v34, v20, -v4
  v_fma_f32 v35, v35, v20, -v4
  v_exp_f32 v32, v32
  v_exp_f32 v33, v33
  v_exp_f32 v34, v34
  v_exp_f32 v35, v35
  v_add_f32 v12, v32, v33
  v_cvt_pk_bf16_f32 v36, v32, v32
  v_add_f32 v13, v34, v35
  v_cvt_pk_bf16_f32 v37, v33, v33
  v_add_f32 v12, v12, v13
  v_cvt_pk_bf16_f32 v38, v34, v34
  v_cvt_pk_bf16_f32 v39, v35, v35
  v_add_f32_dpp v12, v12, v12 quad_perm:[1,0,3,2] row_mask:0xf bank_mask:0xf
  ds_write_b128 v14, v[36:39]
  s_nop 0
  v_add_f32_dpp v12, v12, v12 quad_perm:[2,3,0,1] row_mask:0xf bank_mask:0xf
  s_nop 1
  v_add_f32_dpp v12, v12, v12 row_half_mirror row_mask:0xf bank_mask:0xf
  v_mov_b32 v13, v12
  s_nop 1
  v_permlane32_swap_b32 v12, v13
  v_add_f32 v12, v12, v13
  v_mov_b32 v13, v12
  s_nop 1
  v_permlane16_swap_b32 v12, v13
  v_add_f32 v12, v12, v13
  ds_write_b32 v6, v12 offset:96
  v_mov_b32 v6, 157968
  v_mov_b32 v7, 1
  s_mov_b64 exec, 1
  ds_add_rtn_u32 v7, v6, v7
  s_mov_b64 exec, -1
  s_getreg_b32 s63, hwreg(HW_REG_XCC_ID, 0, 4)
  s_waitcnt lgkmcnt(0)
  v_readfirstlane_b32 s46, v7
  s_nop 0
  s_cmp_lg_u32 s46, 3
  s_cbranch_scc1 L_A_noml
  ds_read_b128 v[12:15], v5 offset:96
  s_xor_b32 s45, s61, s63
  v_mov_b32 v8, v3
  v_mov_b32 v9, s60
  v_mov_b32 v11, s45
  s_lshl_b32 s44, s35, 7
  s_lshl_b32 s45, s33, 4
  s_add_u32 s44, s44, s45
  s_add_u32 s44, s44, 589824
  v_bfe_u32 v5, v0, 3, 1
  v_lshlrev_b32 v5, 6, v5
  v_add_u32 v5, s44, v5
  s_mov_b64 exec, 0x101
  s_waitcnt lgkmcnt(0)
  v_add_f32 v12, v12, v13
  v_add_f32 v14, v14, v15
  v_add_f32 v10, v12, v14
  global_store_dwordx4 v5, v[8:11], s[28:29] sc1
  s_mov_b64 exec, -1
L_A_noml:
  s_lshl_b32 s44, s30, 8
  s_lshl_b32 s45, s3, 6
  s_add_u32 s44, s44, s45
  s_mul_i32 s44, s44, 1152
  s_add_u32 s40, s12, s44
  s_addc_u32 s41, s13, 0
  s_mov_b32 s42, 73728
  v_lshrrev_b32 v20, 3, v0
  v_bfe_u32 v3, v0, 4, 2
  v_lshlrev_b32 v3, 1, v3
  v_and_b32 v4, 7, v0
  v_xor_b32 v3, v3, v4
  v_lshlrev_b32 v3, 4, v3
  v_mul_u32_u24 v20, 1152, v20
  v_add_u32 v20, v20, v3
  v_add_u32 v20, 0x400, v20
  v_and_b32 v3, 15, v0
  v_lshlrev_b32 v3, 4, v3
  v_lshlrev_b32 v4, 5, v2
  v_xor_b32 v3, v3, v4
  v_xor_b32 v4, 0x80, v3
  v_mul_u32_u24 v21, 1152, v2
  s_lshl_b32 s45, s33, 8
  v_add3_u32 v22, v21, v4, s45
  v_add3_u32 v21, v21, v3, s45
  v_add_u32 v22, 4608, v22
  s_mov_b32 s56, s3
  s_cmp_eq_u32 s33, s32
  s_cselect_b32 s57, 1, 0
  v_mov_b32 v6, 157968
LW_12:
  ds_read_b32 v7, v6
  s_add_u32 s62, s62, 1
  s_cmp_gt_u32 s62, 0x2000000
  s_cbranch_scc1 L_end
  s_waitcnt lgkmcnt(0)
  v_readfirstlane_b32 s46, v7
  s_nop 0
  s_cmp_lt_u32 s46, 4
  s_cbranch_scc1 LW_12
  s_lshl_b32 m0, s3, 14
  s_mov_b32 s44, 0
L_woloop:
  buffer_load_dwordx4 v21, s[40:43], s44 offen  lds
  s_add_u32 m0, m0, 0x400
  s_nop 0
  buffer_load_dwordx4 v22, s[40:43], s44 offen  lds
  s_add_u32 m0, m0, 0x400
  s_add_u32 s44, s44, 9216
  s_cmp_lt_u32 s44, 73728
  s_cbranch_scc1 L_woloop
  s_cmp_eq_u32 s57, 0
  s_cbranch_scc1 L_wo8done
L_wo8start:
  s_lshl_b32 s44, s3, 13
  s_add_u32 m0, s44, 65536
  s_mov_b32 s44, 0
L_wo8:
  buffer_load_dwordx4 v20, s[40:43], s44 offen  lds
  s_add_u32 m0, m0, 0x400
  s_add_u32 s44, s44, 9216
  s_cmp_lt_u32 s44, 73728
  s_cbranch_scc1 L_wo8
L_wo8done:
  s_cmp_lg_u32 s3, 0
  s_cbranch_scc1 L_A_wowait
  s_lshl_b32 s44, s35, 12
  s_lshl_b32 s45, s33, 10
  s_add_u32 s44, s44, s45
  s_add_u32 s44, s44, 655360
  v_add_u32 v3, s44, v1
  global_load_dwordx4 v[24:27], v3, s[28:29] sc1
  s_lshl_b32 s45, s35, 7
  s_add_u32 s45, s45, 589824
  s_add_u32 s48, s28, s45
  s_addc_u32 s49, s29, 0
  v_subrev_u32 v15, s33, v2
  v_and_b32 v15, 3, v15
  v_lshlrev_b32 v15, 2, v15
  v_add_u32 v15, 158080, v15
  s_mov_b32 s58, 0
L_mlpoll:
  s_load_dwordx16 s[4:19], s[48:49], 0 glc
  s_add_u32 s62, s62, 4
  s_cmp_gt_u32 s62, 0x2000000
  s_cbranch_scc1 L_end
  s_sleep 2
  s_waitcnt lgkmcnt(0)
  s_mov_b32 s44, 0
  s_mov_b32 s47, 0
  s_xor_b32 s45, s5, s60
  s_or_b32 s44, s44, s45
  s_xor_b32 s45, s7, s61
  s_xor_b32 s46, s45, s63
  s_or_b32 s47, s47, s46
  s_lshr_b32 s45, s45, 4
  s_or_b32 s44, s44, s45
  s_xor_b32 s45, s9, s60
  s_or_b32 s44, s44, s45
  s_xor_b32 s45, s11, s61
  s_xor_b32 s46, s45, s63
  s_or_b32 s47, s47, s46
  s_lshr_b32 s45, s45, 4
  s_or_b32 s44, s44, s45
  s_xor_b32 s45, s13, s60
  s_or_b32 s44, s44, s45
  s_xor_b32 s45, s15, s61
  s_xor_b32 s46, s45, s63
  s_or_b32 s47, s47, s46
  s_lshr_b32 s45, s45, 4
  s_or_b32 s44, s44, s45
  s_xor_b32 s45, s17, s60
  s_or_b32 s44, s44, s45
  s_xor_b32 s45, s19, s61
  s_xor_b32 s46, s45, s63
  s_or_b32 s47, s47, s46
  s_lshr_b32 s45, s45, 4
  s_or_b32 s44, s44, s45
  s_cbranch_scc1 L_mlpoll
  v_mov_b32 v8, s4
  v_mov_b32 v10, s6
  v_mov_b32 v9, s8
  v_mov_b32 v11, s10
  v_cmp_eq_u32 vcc, 1, v2
  v_mov_b32 v12, s12
  v_mov_b32 v13, s14
  v_cndmask_b32 v8, v8, v9, vcc
  v_cndmask_b32 v10, v10, v11, vcc
  v_cmp_eq_u32 vcc, 2, v2
  v_mov_b32 v9, s16
  v_mov_b32 v11, s18
  v_cndmask_b32 v8, v8, v12, vcc
  v_cndmask_b32 v10, v10, v13, vcc
  v_cmp_eq_u32 vcc, 3, v2
  s_nop 1
  v_cndmask_b32 v8, v8, v9, vcc
  v_cndmask_b32 v10, v10, v11, vcc
  v_mov_b32 v12, v8
  v_mov_b32 v13, v12
  s_nop 1
  v_permlane32_swap_b32 v12, v13
  v_max_f32 v12, v12, v13
  v_mov_b32 v13, v12
  s_nop 1
  v_permlane16_swap_b32 v12, v13
  v_max_f32 v12, v12, v13
  v_sub_f32 v12, v8, v12
  v_mul_f32 v12, 0x3fb8aa3b, v12
  v_exp_f32 v12, v12
  s_nop 0
  v_mul_f32 v13, v12, v10
  v_mov_b32 v14, v13
  s_nop 1
  v_permlane32_swap_b32 v13, v14
  v_add_f32 v13, v13, v14
  v_mov_b32 v14, v13
  s_nop 1
  v_permlane16_swap_b32 v13, v14
  v_add_f32 v13, v13, v14
  v_rcp_f32 v13, v13
  s_add_u32 s48, s48, 64
  s_addc_u32 s49, s49, 0
  v_mul_f32 v12, v12, v13
  ds_write_b32 v15, v12
  v_add_u32 v15, 16, v15
  s_add_u32 s58, s58, 1
  s_cmp_lt_u32 s58, 2
  s_cbranch_scc1 L_mlpoll
  s_cmp_eq_u32 s47, 0
  s_cselect_b32 s44, 2, 1
  v_mov_b32 v8, 158000
  v_mov_b32 v9, s44
  ds_write_b32 v8, v9
L_A_wowait:
  s_waitcnt vmcnt(0)
  v_mov_b32 v6, 157972
  v_mov_b32 v7, 1
  s_mov_b64 exec, 1
  ds_add_u32 v6, v7
  s_mov_b64 exec, -1
  s_branch L_proj
L_ln:
  v_add_f32 v31, v22, v23
  v_add_f32 v32, v24, v25
  v_add_f32 v33, v26, v27
  v_add_f32 v31, v31, v32
  v_add_f32 v32, v28, v29
  v_add_f32 v33, v33, v30
  v_add_f32 v31, v31, v32
  v_add_f32 v31, v31, v33
  s_nop 1
  v_add_f32_dpp v31, v31, v31 quad_perm:[1,0,3,2] row_mask:0xf bank_mask:0xf
  s_nop 1
  v_add_f32_dpp v31, v31, v31 quad_perm:[2,3,0,1] row_mask:0xf bank_mask:0xf
  s_nop 1
  v_add_f32_dpp v31, v31, v31 row_half_mirror row_mask:0xf bank_mask:0xf
  s_nop 1
  v_add_f32_dpp v31, v31, v31 row_mirror row_mask:0xf bank_mask:0xf
  s_nop 1
  v_add_f32_dpp v31, v31, v31 row_bcast:15 row_mask:0xa bank_mask:0xf
  s_nop 1
  v_add_f32_dpp v31, v31, v31 row_bcast:31 row_mask:0xc bank_mask:0xf
  s_nop 0
  v_readlane_b32 s44, v31, 63
  s_nop 1
  v_mov_b32 v31, 0x3ae38e39
  v_mul_f32 v31, s44, v31
  v_mov_b32 v32, 0
  v_sub_f32 v33, v22, v31
  v_fmac_f32 v32, v33, v33
  v_sub_f32 v33, v23, v31
  v_fmac_f32 v32, v33, v33
  v_sub_f32 v33, v24, v31
  v_fmac_f32 v32, v33, v33
  v_sub_f32 v33, v25, v31
  v_fmac_f32 v32, v33, v33
  v_sub_f32 v33, v26, v31
  v_fmac_f32 v32, v33, v33
  v_sub_f32 v33, v27, v31
  v_fmac_f32 v32, v33, v33
  v_sub_f32 v33, v28, v31
  v_fmac_f32 v32, v33, v33
  v_sub_f32 v33, v29, v31
  v_fmac_f32 v32, v33, v33
  v_sub_f32 v33, v30, v31
  v_fmac_f32 v32, v33, v33
  s_nop 1
  v_add_f32_dpp v32, v32, v32 quad_perm:[1,0,3,2] row_mask:0xf bank_mask:0xf
  s_nop 1
  v_add_f32_dpp v32, v32, v32 quad_perm:[2,3,0,1] row_mask:0xf bank_mask:0xf
  s_nop 1
  v_add_f32_dpp v32, v32, v32 row_half_mirror row_mask:0xf bank_mask:0xf
  s_nop 1
  v_add_f32_dpp v32, v32, v32 row_mirror row_mask:0xf bank_mask:0xf
  s_nop 1
  v_add_f32_dpp v32, v32, v32 row_bcast:15 row_mask:0xa bank_mask:0xf
  s_nop 1
  v_add_f32_dpp v32, v32, v32 row_bcast:31 row_mask:0xc bank_mask:0xf
  s_nop 0
  v_readlane_b32 s45, v32, 63
  s_nop 1
  v_cvt_pk_bf16_f32 v31, v31, v31
  v_and_b32 v31, 0xffff0000, v31
  v_mov_b32 v32, 0x3ae38e39
  v_mul_f32 v32, s45, v32
  v_cvt_pk_bf16_f32 v32, v32, v32
  v_and_b32 v32, 0xffff0000, v32
  v_add_f32 v32, 0x3727c5ac, v32
  v_cvt_pk_bf16_f32 v32, v32, v32
  v_and_b32 v32, 0xffff0000, v32
  v_sqrt_f32 v32, v32
  s_nop 0
  v_cvt_pk_bf16_f32 v32, v32, v32
  v_and_b32 v32, 0xffff0000, v32
  v_rcp_f32 v32, v32
  v_sub_f32 v22, v22, v31
  v_sub_f32 v23, v23, v31
  v_sub_f32 v24, v24, v31
  v_sub_f32 v25, v25, v31
  v_sub_f32 v26, v26, v31
  v_sub_f32 v27, v27, v31
  v_sub_f32 v28, v28, v31
  v_sub_f32 v29, v29, v31
  v_sub_f32 v30, v30, v31
  v_cvt_pk_bf16_f32 v23, v22, v23
  v_lshlrev_b32 v22, 16, v23
  v_and_b32 v23, 0xffff0000, v23
  v_cvt_pk_bf16_f32 v25, v24, v25
  v_lshlrev_b32 v24, 16, v25
  v_and_b32 v25, 0xffff0000, v25
  v_cvt_pk_bf16_f32 v27, v26, v27
  v_lshlrev_b32 v26, 16, v27
  v_and_b32 v27, 0xffff0000, v27
  v_cvt_pk_bf16_f32 v29, v28, v29
  v_lshlrev_b32 v28, 16, v29
  v_and_b32 v29, 0xffff0000, v29
  v_cvt_pk_bf16_f32 v30, v30, v30
  v_and_b32 v30, 0xffff0000, v30
  v_mul_f32 v22, v22, v32
  v_mul_f32 v23, v23, v32
  v_mul_f32 v24, v24, v32
  v_mul_f32 v25, v25, v32
  v_mul_f32 v26, v26, v32
  v_mul_f32 v27, v27, v32
  v_mul_f32 v28, v28, v32
  v_mul_f32 v29, v29, v32
  v_mul_f32 v30, v30, v32
  v_cvt_pk_bf16_f32 v23, v22, v23
  v_lshlrev_b32 v22, 16, v23
  v_and_b32 v23, 0xffff0000, v23
  v_cvt_pk_bf16_f32 v25, v24, v25
  v_lshlrev_b32 v24, 16, v25
  v_and_b32 v25, 0xffff0000, v25
  v_cvt_pk_bf16_f32 v27, v26, v27
  v_lshlrev_b32 v26, 16, v27
  v_and_b32 v27, 0xffff0000, v27
  v_cvt_pk_bf16_f32 v29, v28, v29
  v_lshlrev_b32 v28, 16, v29
  v_and_b32 v29, 0xffff0000, v29
  v_cvt_pk_bf16_f32 v30, v30, v30
  v_and_b32 v30, 0xffff0000, v30
  s_setpc_b64 s[50:51]
L_M2:
  s_mul_i32 s58, s96, 1821
  s_lshr_b32 s58, s58, 16
  s_mul_i32 s59, s58, 36
  s_sub_u32 s59, s96, s59
  s_lshl_b32 s44, s34, 6
  v_add_u32 v13, s44, v0
  v_lshlrev_b32 v14, 2, v13
  v_lshlrev_b32 v13, 4, v13
  v_add_u32 v15, 0x1000, v13
  v_add_u32 v14, 0x2000, v14
  v_and_b32 v92, 7, v0
  v_lshrrev_b32 v3, 5, v0
  v_lshl_add_u32 v92, v92, 1, v3
  s_mul_i32 s44, s58, 1152
  s_lshl_b32 s45, s59, 5
  s_add_u32 s44, s44, s45
  v_lshlrev_b32 v93, 1, v92
  v_add_u32 v93, s44, v93
  v_mov_b32 v95, 0
  v_mov_b32 v4, 157952
LW_13:
  ds_read_b32 v5, v4
  s_add_u32 s62, s62, 1
  s_cmp_gt_u32 s62, 0x2000000
  s_cbranch_scc1 L_end
  s_sleep 1
  s_waitcnt lgkmcnt(0)
  v_readfirstlane_b32 s46, v5
  s_nop 0
  s_cmp_lt_u32 s46, 4
  s_cbranch_scc1 LW_13
  global_load_dwordx4 v[96:99], v13, s[16:17]
  global_load_dwordx4 v[100:103], v15, s[16:17]
  global_load_dword v104, v14, s[16:17]
  global_load_dwordx4 v[106:109], v13, s[18:19]
  global_load_dwordx4 v[110:113], v15, s[18:19]
  global_load_dword v114, v14, s[18:19]
  global_load_dwordx4 v[116:119], v13, s[20:21]
  global_load_dwordx4 v[120:123], v15, s[20:21]
  global_load_dword v124, v14, s[20:21]
  global_load_ushort v94, v93, s[4:5]
  global_load_ushort v95, v95, s[22:23]
  v_mov_b32 v4, 158016
  ds_read_b64 v[4:5], v4
  s_waitcnt lgkmcnt(0)
  v_readfirstlane_b32 s60, v4
  v_readfirstlane_b32 s61, v5
  s_nop 1
  s_mul_i32 s44, s58, 1152
  s_add_u32 s44, s44, 149504
  v_lshlrev_b32 v14, 1, v0
  v_add_u32 v11, s44, v1
  v_add_u32 v12, s44, v14
  ds_read_b128 v[16:19], v11
  ds_read_u16 v20, v12 offset:1024
  s_waitcnt lgkmcnt(0)
  v_lshlrev_b32 v22, 16, v16
  v_and_b32 v23, 0xffff0000, v16
  v_lshlrev_b32 v24, 16, v17
  v_and_b32 v25, 0xffff0000, v17
  v_lshlrev_b32 v26, 16, v18
  v_and_b32 v27, 0xffff0000, v18
  v_lshlrev_b32 v28, 16, v19
  v_and_b32 v29, 0xffff0000, v19
  v_lshlrev_b32 v30, 16, v20
  s_call_b64 s[50:51], L_ln
  v_lshlrev_b32 v11, 5, v0
  v_add_u32 v11, 154112, v11
  v_lshlrev_b32 v12, 2, v0
  v_add_u32 v12, 154112, v12
  ds_write_b128 v11, v[22:25]
  ds_write_b128 v11, v[26:29] offset:16
  ds_write_b32 v12, v30 offset:2048
  s_lshl_b32 s44, s59, 6
  s_add_u32 s44, s44, 154112
  v_mov_b32 v15, s44
  s_waitcnt vmcnt(0)
  v_lshlrev_b32 v32, 16, v96
  v_and_b32 v33, 0xffff0000, v96
  v_lshlrev_b32 v34, 16, v97
  v_and_b32 v35, 0xffff0000, v97
  v_lshlrev_b32 v36, 16, v98
  v_and_b32 v37, 0xffff0000, v98
  v_lshlrev_b32 v38, 16, v99
  v_and_b32 v39, 0xffff0000, v99
  v_lshlrev_b32 v40, 16, v100
  v_and_b32 v41, 0xffff0000, v100
  v_lshlrev_b32 v42, 16, v101
  v_and_b32 v43, 0xffff0000, v101
  v_lshlrev_b32 v44, 16, v102
  v_and_b32 v45, 0xffff0000, v102
  v_lshlrev_b32 v46, 16, v103
  v_and_b32 v47, 0xffff0000, v103
  v_lshlrev_b32 v48, 16, v104
  v_and_b32 v49, 0xffff0000, v104
  v_lshlrev_b32 v50, 16, v106
  v_and_b32 v51, 0xffff0000, v106
  v_lshlrev_b32 v52, 16, v107
  v_and_b32 v53, 0xffff0000, v107
  v_lshlrev_b32 v54, 16, v108
  v_and_b32 v55, 0xffff0000, v108
  v_lshlrev_b32 v56, 16, v109
  v_and_b32 v57, 0xffff0000, v109
  v_lshlrev_b32 v58, 16, v110
  v_and_b32 v59, 0xffff0000, v110
  v_lshlrev_b32 v60, 16, v111
  v_and_b32 v61, 0xffff0000, v111
  v_lshlrev_b32 v62, 16, v112
  v_and_b32 v63, 0xffff0000, v112
  v_lshlrev_b32 v64, 16, v113
  v_and_b32 v65, 0xffff0000, v113
  v_lshlrev_b32 v66, 16, v114
  v_and_b32 v67, 0xffff0000, v114
  v_lshlrev_b32 v68, 16, v116
  v_and_b32 v69, 0xffff0000, v116
  v_lshlrev_b32 v70, 16, v117
  v_and_b32 v71, 0xffff0000, v117
  v_lshlrev_b32 v72, 16, v118
  v_and_b32 v73, 0xffff0000, v118
  v_lshlrev_b32 v74, 16, v119
  v_and_b32 v75, 0xffff0000, v119
  v_lshlrev_b32 v76, 16, v120
  v_and_b32 v77, 0xffff0000, v120
  v_lshlrev_b32 v78, 16, v121
  v_and_b32 v79, 0xffff0000, v121
  v_lshlrev_b32 v80, 16, v122
  v_and_b32 v81, 0xffff0000, v122
  v_lshlrev_b32 v82, 16, v123
  v_and_b32 v83, 0xffff0000, v123
  v_lshlrev_b32 v84, 16, v124
  v_and_b32 v85, 0xffff0000, v124
  v_mov_b32 v30, 0xc0135761
  v_mov_b32 v31, 0xbdd2d3e8
  s_lshl_b32 s44, s34, 4
  s_add_u32 s44, s44, 156928
  v_lshlrev_b32 v14, 2, v2
  v_add_u32 v14, s44, v14
  s_mov_b32 s47, 0
  s_mov_b32 s48, 0x00010001
  s_mov_b32 s49, 0x00010001
  s_waitcnt lgkmcnt(0)
  ds_read_b32 v4, v15
L_mlp:
  v_mov_b32 v6, 0
  v_mov_b32 v7, 0
  s_waitcnt lgkmcnt(0)
  v_pk_fma_f32 v[8:9], v[32:33], v[4:5], v[50:51] op_sel_hi:[1,0,1]
  v_pk_fma_f32 v[10:11], v[34:35], v[4:5], v[52:53] op_sel_hi:[1,0,1]
  v_pk_fma_f32 v[12:13], v[36:37], v[4:5], v[54:55] op_sel_hi:[1,0,1]
  v_pk_mul_f32 v[16:17], v[8:9], v[8:9]
  v_pk_mul_f32 v[18:19], v[10:11], v[10:11]
  v_pk_mul_f32 v[20:21], v[12:13], v[12:13]
  v_pk_fma_f32 v[16:17], v[16:17], v[30:31], v[30:31] op_sel:[0,1,0] op_sel_hi:[1,1,0]
  v_pk_fma_f32 v[18:19], v[18:19], v[30:31], v[30:31] op_sel:[0,1,0] op_sel_hi:[1,1,0]
  v_pk_fma_f32 v[20:21], v[20:21], v[30:31], v[30:31] op_sel:[0,1,0] op_sel_hi:[1,1,0]
  v_pk_mul_f32 v[16:17], v[16:17], v[8:9]
  v_pk_mul_f32 v[18:19], v[18:19], v[10:11]
  v_pk_mul_f32 v[20:21], v[20:21], v[12:13]
  v_exp_f32 v16, v16
  v_exp_f32 v17, v17
  v_exp_f32 v18, v18
  v_exp_f32 v19, v19
  v_exp_f32 v20, v20
  v_exp_f32 v21, v21
  v_pk_mul_f32 v[8:9], v[8:9], v[68:69]
  v_pk_mul_f32 v[10:11], v[10:11], v[70:71]
  v_pk_mul_f32 v[12:13], v[12:13], v[72:73]
  v_pk_add_f32 v[16:17], v[16:17], 1.0 op_sel_hi:[1,0]
  v_pk_add_f32 v[18:19], v[18:19], 1.0 op_sel_hi:[1,0]
  v_pk_add_f32 v[20:21], v[20:21], 1.0 op_sel_hi:[1,0]
  v_rcp_f32 v16, v16
  v_rcp_f32 v17, v17
  v_rcp_f32 v18, v18
  v_rcp_f32 v19, v19
  v_rcp_f32 v20, v20
  v_rcp_f32 v21, v21
  s_nop 0
  v_pk_fma_f32 v[6:7], v[8:9], v[16:17], v[6:7]
  v_pk_fma_f32 v[6:7], v[10:11], v[18:19], v[6:7]
  v_pk_fma_f32 v[6:7], v[12:13], v[20:21], v[6:7]
  v_pk_fma_f32 v[8:9], v[38:39], v[4:5], v[56:57] op_sel_hi:[1,0,1]
  v_pk_fma_f32 v[10:11], v[40:41], v[4:5], v[58:59] op_sel_hi:[1,0,1]
  v_pk_fma_f32 v[12:13], v[42:43], v[4:5], v[60:61] op_sel_hi:[1,0,1]
  v_pk_mul_f32 v[16:17], v[8:9], v[8:9]
  v_pk_mul_f32 v[18:19], v[10:11], v[10:11]
  v_pk_mul_f32 v[20:21], v[12:13], v[12:13]
  v_pk_fma_f32 v[16:17], v[16:17], v[30:31], v[30:31] op_sel:[0,1,0] op_sel_hi:[1,1,0]
  v_pk_fma_f32 v[18:19], v[18:19], v[30:31], v[30:31] op_sel:[0,1,0] op_sel_hi:[1,1,0]
  v_pk_fma_f32 v[20:21], v[20:21], v[30:31], v[30:31] op_sel:[0,1,0] op_sel_hi:[1,1,0]
  v_pk_mul_f32 v[16:17], v[16:17], v[8:9]
  v_pk_mul_f32 v[18:19], v[18:19], v[10:11]
  v_pk_mul_f32 v[20:21], v[20:21], v[12:13]
  v_exp_f32 v16, v16
  v_exp_f32 v17, v17
  v_exp_f32 v18, v18
  v_exp_f32 v19, v19
  v_exp_f32 v20, v20
  v_exp_f32 v21, v21
  v_pk_mul_f32 v[8:9], v[8:9], v[74:75]
  v_pk_mul_f32 v[10:11], v[10:11], v[76:77]
  v_pk_mul_f32 v[12:13], v[12:13], v[78:79]
  v_pk_add_f32 v[16:17], v[16:17], 1.0 op_sel_hi:[1,0]
  v_pk_add_f32 v[18:19], v[18:19], 1.0 op_sel_hi:[1,0]
  v_pk_add_f32 v[20:21], v[20:21], 1.0 op_sel_hi:[1,0]
  v_rcp_f32 v16, v16
  v_rcp_f32 v17, v17
  v_rcp_f32 v18, v18
  v_rcp_f32 v19, v19
  v_rcp_f32 v20, v20
  v_rcp_f32 v21, v21
  s_nop 0
  v_pk_fma_f32 v[6:7], v[8:9], v[16:17], v[6:7]
  v_pk_fma_f32 v[6:7], v[10:11], v[18:19], v[6:7]
  v_pk_fma_f32 v[6:7], v[12:13], v[20:21], v[6:7]
  v_pk_fma_f32 v[8:9], v[44:45], v[4:5], v[62:63] op_sel_hi:[1,0,1]
  v_pk_fma_f32 v[10:11], v[46:47], v[4:5], v[64:65] op_sel_hi:[1,0,1]
  v_pk_fma_f32 v[12:13], v[48:49], v[4:5], v[66:67] op_sel_hi:[1,0,1]
  v_pk_mul_f32 v[16:17], v[8:9], v[8:9]
  v_pk_mul_f32 v[18:19], v[10:11], v[10:11]
  v_pk_mul_f32 v[20:21], v[12:13], v[12:13]
  v_pk_fma_f32 v[16:17], v[16:17], v[30:31], v[30:31] op_sel:[0,1,0] op_sel_hi:[1,1,0]
  v_pk_fma_f32 v[18:19], v[18:19], v[30:31], v[30:31] op_sel:[0,1,0] op_sel_hi:[1,1,0]
  v_pk_fma_f32 v[20:21], v[20:21], v[30:31], v[30:31] op_sel:[0,1,0] op_sel_hi:[1,1,0]
  v_pk_mul_f32 v[16:17], v[16:17], v[8:9]
  v_pk_mul_f32 v[18:19], v[18:19], v[10:11]
  v_pk_mul_f32 v[20:21], v[20:21], v[12:13]
  v_exp_f32 v16, v16
  v_exp_f32 v17, v17
  v_exp_f32 v18, v18
  v_exp_f32 v19, v19
  v_exp_f32 v20, v20
  v_exp_f32 v21, v21
  v_pk_mul_f32 v[8:9], v[8:9], v[80:81]
  v_pk_mul_f32 v[10:11], v[10:11], v[82:83]
  v_pk_mul_f32 v[12:13], v[12:13], v[84:85]
  v_pk_add_f32 v[16:17], v[16:17], 1.0 op_sel_hi:[1,0]
  v_pk_add_f32 v[18:19], v[18:19], 1.0 op_sel_hi:[1,0]
  v_pk_add_f32 v[20:21], v[20:21], 1.0 op_sel_hi:[1,0]
  v_rcp_f32 v16, v16
  v_rcp_f32 v17, v17
  v_rcp_f32 v18, v18
  v_rcp_f32 v19, v19
  v_rcp_f32 v20, v20
  v_rcp_f32 v21, v21
  v_add_u32 v15, 4, v15
  ds_read_b32 v4, v15
  v_pk_fma_f32 v[6:7], v[8:9], v[16:17], v[6:7]
  v_pk_fma_f32 v[6:7], v[10:11], v[18:19], v[6:7]
  v_pk_fma_f32 v[6:7], v[12:13], v[20:21], v[6:7]
  v_add_f32 v6, v6, v7
  s_nop 1
  v_add_f32_dpp v6, v6, v6 quad_perm:[1,0,3,2] row_mask:0xf bank_mask:0xf
  s_nop 1
  v_add_f32_dpp v6, v6, v6 quad_perm:[2,3,0,1] row_mask:0xf bank_mask:0xf
  s_nop 1
  v_add_f32_dpp v6, v6, v6 row_half_mirror row_mask:0xf bank_mask:0xf
  s_nop 1
  v_add_f32_dpp v6, v6, v6 row_mirror row_mask:0xf bank_mask:0xf
  s_mov_b64 exec, s[48:49]
  ds_write_b32 v14, v6
  s_mov_b64 exec, -1
  v_add_u32 v14, 64, v14
  s_add_u32 s47, s47, 1
  s_cmp_lt_u32 s47, 16
  s_cbranch_scc1 L_mlp
  s_waitcnt lgkmcnt(0)
  v_mov_b32 v8, 157984
  v_mov_b32 v9, 1
  s_mov_b64 exec, 1
  ds_add_u32 v8, v9
  s_mov_b64 exec, -1
  s_cmp_lg_u32 s34, 0
  s_cbranch_scc1 L_end
  s_setprio 3
  v_lshlrev_b32 v6, 6, v92
  v_add_u32 v6, 156928, v6
  s_lshl_b32 s44, s96, 11
  s_add_u32 s44, s44, 1310720
  v_add_u32 v7, s44, v1
  global_load_dwordx4 v[32:35], v7, s[28:29] sc1
  global_load_dwordx4 v[36:39], v7, s[28:29] offset:1024 sc1
  v_mov_b32 v8, 157984
LW_14:
  ds_read_b32 v9, v8
  s_add_u32 s62, s62, 1
  s_cmp_gt_u32 s62, 0x2000000
  s_cbranch_scc1 L_end
  s_sleep 1
  s_waitcnt lgkmcnt(0)
  v_readfirstlane_b32 s46, v9
  s_nop 0
  s_cmp_lt_u32 s46, 4
  s_cbranch_scc1 LW_14
  ds_read_b128 v[8:11], v6
  ds_read_b128 v[12:15], v6 offset:16
  ds_read_b128 v[16:19], v6 offset:32
  ds_read_b128 v[20:23], v6 offset:48
  s_waitcnt lgkmcnt(0)
  v_add_f32 v8, v8, v9
  v_add_f32 v8, v8, v10
  v_add_f32 v8, v8, v11
  v_add_f32 v8, v8, v12
  v_add_f32 v8, v8, v13
  v_add_f32 v8, v8, v14
  v_add_f32 v8, v8, v15
  v_add_f32 v8, v8, v16
  v_add_f32 v8, v8, v17
  v_add_f32 v8, v8, v18
  v_add_f32 v8, v8, v19
  v_add_f32 v8, v8, v20
  v_add_f32 v8, v8, v21
  v_add_f32 v8, v8, v22
  v_add_f32 v8, v8, v23
  v_cvt_pk_bf16_f32 v8, v8, v8
  v_and_b32 v8, 0xffff0000, v8
  v_lshlrev_b32 v4, 16, v94
  v_lshlrev_b32 v5, 16, v95
  v_add_f32 v8, v8, v5
  v_cvt_pk_bf16_f32 v8, v8, v8
  v_and_b32 v8, 0xffff0000, v8
  v_mul_f32 v9, 0xbfb8aa3b, v8
  v_exp_f32 v9, v9
  s_nop 0
  v_add_f32 v9, 1.0, v9
  v_rcp_f32 v9, v9
  s_nop 0
  v_mul_f32 v5, v8, v9
  v_cvt_pk_bf16_f32 v5, v5, v5
  v_and_b32 v5, 0xffff0000, v5
  v_bfe_u32 v8, v0, 3, 2
  v_cmp_eq_u32 s[52:53], 0, v8
  s_waitcnt vmcnt(0)
  v_mov_b32 v8, 157980
LW_15:
  ds_read_b32 v9, v8
  s_add_u32 s62, s62, 1
  s_cmp_gt_u32 s62, 0x2000000
  s_cbranch_scc1 L_end
  s_sleep 1
  s_waitcnt lgkmcnt(0)
  v_readfirstlane_b32 s46, v9
  s_nop 0
  s_cmp_lt_u32 s46, 1
  s_cbranch_scc1 LW_15
  global_load_dwordx4 v[32:35], v7, s[28:29] sc1
  global_load_dwordx4 v[36:39], v7, s[28:29] offset:1024 sc1
L_spoll:
  global_load_dwordx4 v[32:35], v7, s[28:29] sc1
  global_load_dwordx4 v[36:39], v7, s[28:29] offset:1024 sc1
  s_add_u32 s62, s62, 4
  s_cmp_gt_u32 s62, 0x2000000
  s_cbranch_scc1 L_end
  s_waitcnt vmcnt(2)
  v_xor_b32 v16, s60, v33
  v_xor_b32 v17, s61, v35
  v_or_b32 v16, v16, v17
  v_xor_b32 v17, s60, v37
  v_xor_b32 v18, s61, v39
  v_or3_b32 v16, v16, v17, v18
  v_cmp_ne_u32 vcc, 0, v16
  s_mov_b64 exec, vcc
  s_cbranch_vccnz L_spoll
  s_mov_b64 exec, -1
  v_add_f32 v10, v32, v36
  v_add_f32 v11, v34, v38
  s_nop 1
  v_permlane32_swap_b32 v10, v11
  v_add_f32 v10, v10, v11
  v_mov_b32 v11, v10
  s_nop 1
  v_permlane16_swap_b32 v10, v11
  v_add_f32 v10, v10, v11
  s_nop 1
  v_add_f32_dpp v10, v10, v10 row_ror:8 row_mask:0xf bank_mask:0xf
  v_cvt_pk_bf16_f32 v10, v10, v10
  v_and_b32 v10, 0xffff0000, v10
  v_mul_f32 v10, v10, v5
  v_cvt_pk_bf16_f32 v10, v10, v10
  v_and_b32 v10, 0xffff0000, v10
  v_add_f32 v10, v10, v4
  v_cvt_pk_bf16_f32 v10, v10, v10
  s_mov_b64 exec, s[52:53]
  global_store_short v93, v10, s[24:25]
  s_mov_b64 exec, -1
  s_cmp_lg_u32 s96, 0
  s_cbranch_scc1 L_end
  v_mov_b32 v8, 0
  v_mov_b32 v10, s60
  v_mov_b32 v11, s61
  s_mov_b64 exec, 1
  global_store_dwordx2 v8, v[10:11], s[28:29] offset:0
  s_mov_b64 exec, -1
L_end:
L_exit:
  s_endpgm
L_code_end:
.section .rodata,"a"
.p2align 6
.amdhsa_kernel recurrent_scan__sliding_block_cached__mixer_token_mlp__decode_kernel
  .amdhsa_next_free_vgpr 128
  .amdhsa_next_free_sgpr 100
  .amdhsa_accum_offset 128
  .amdhsa_group_segment_fixed_size 0
  .amdhsa_kernarg_size 104
  .amdhsa_user_sgpr_count 2
  .amdhsa_user_sgpr_kernarg_segment_ptr 1
  .amdhsa_system_sgpr_workgroup_id_x 1
.end_amdhsa_kernel
```
